```python
import torch

def _softmax(x, axis=-1):
    return torch.softmax(x, dim=axis)
def _gelu(x):
    return torch.nn.functional.gelu(x, approximate="tanh")
def _silu(x):
    return torch.nn.functional.silu(x)
def _sigmoid(x):
    return torch.sigmoid(x)
def _layernorm(x, axis=-1, eps=1e-5):
    m = x.mean(dim=axis, keepdim=True)
    v = x.var(dim=axis, keepdim=True, unbiased=False)
    return (x - m) / torch.sqrt(v + eps)
def _scatter_add(tgt, idx, src, axis=0):
    return tgt.clone().index_add_(axis, idx, src)
def _segment_sum(src, seg, n):
    out = torch.zeros((n,) + src.shape[1:], dtype=src.dtype)
    return out.index_add_(0, seg, src)
def _pad(x, pw):
    flat = tuple(v for pair in reversed(pw) for v in pair)
    return torch.nn.functional.pad(x, flat)

kernel_name = 'parallel_sum__linear_kernel_hedgehog__dense_activation_squared_relu__prompt'

def setup_inputs():

    _w = (lambda a: (lambda t: t.to(torch.bfloat16) if t.is_floating_point() else t)(torch.as_tensor(a)))
    def _A_setup():
        B, S, D, H = 1, 2048, 640, 32
        Dh = D // H
        return {
            "x": _w((lambda *s: torch.randn(*s, dtype=torch.bfloat16) * 0.05)(B, S, D)),
            "wqkv": _w((lambda *s: torch.randn(*s, dtype=torch.bfloat16) * 0.8)(D, 3 * D)),
            "w_phi": _w((lambda *s: torch.randn(*s, dtype=torch.bfloat16) * 0.8)(H, Dh, Dh) * (Dh ** -0.5)),
            "wo": _w((lambda *s: torch.randn(*s, dtype=torch.bfloat16) * 0.2)(D, D)),
        }
    _A_in = _A_setup()

    def _B_setup():
        B, S, D, F = 1, 2048, 640, 1728
        return {
            "x": _w((lambda *s: torch.randn(*s, dtype=torch.bfloat16) * 0.05)(B, S, D)),
            "w1": _w((lambda *s: torch.randn(*s, dtype=torch.bfloat16) * 0.05)(D, F)),
            "b1": _w((lambda *s: torch.randn(*s, dtype=torch.bfloat16) * 0.8)(F)),
            "w2": _w((lambda *s: torch.randn(*s, dtype=torch.bfloat16) * 0.05)(F, D)),
            "b2": _w((lambda *s: torch.randn(*s, dtype=torch.bfloat16) * 3.2)(D)),
        }
    _B_in = _B_setup()

    return {
        "A_x": _A_in["x"],
        "A_wqkv": _A_in["wqkv"],
        "A_w_phi": _A_in["w_phi"],
        "A_wo": _A_in["wo"],
        "B_x": _B_in["x"],
        "B_w1": _B_in["w1"],
        "B_b1": _B_in["b1"],
        "B_w2": _B_in["w2"],
        "B_b2": _B_in["b2"],
    }

def reference(A_x, A_wqkv, A_w_phi, A_wo, B_x, B_w1, B_b1, B_w2, B_b2):
    def _A_ref(x, wqkv, w_phi, wo):
        B, S, D = x.shape
        H = 32; Dh = D // H
        qkv = (lambda x, *d: x.permute(*d))((x @ wqkv).reshape(B, S, 3, H, Dh), 2, 0, 3, 1, 4)
        q, k, v = qkv[0], qkv[1], qkv[2]
        pq = torch.einsum("bhsd,hdf->bhsf", q, w_phi)
        pk = torch.einsum("bhsd,hdf->bhsf", k, w_phi)
        phi_q = torch.concatenate([_softmax(pq, axis=-1), _softmax(-pq, axis=-1)], axis=-1)
        phi_k = torch.concatenate([_softmax(pk, axis=-1), _softmax(-pk, axis=-1)], axis=-1)
        kv = torch.einsum("bhsf,bhsd->bhfd", phi_k, v)
        z  = torch.einsum("bhsf->bhf", phi_k)
        num = torch.einsum("bhqf,bhfd->bhqd", phi_q, kv)
        den = torch.einsum("bhqf,bhf->bhq", phi_q, z)[..., None] + 1e-6
        o = num / den
        return (lambda x, *d: x.permute(*d))(o, 0, 2, 1, 3).reshape(B, S, D) @ wo

    def _B_ref(x, w1, b1, w2, b2):
        h = torch.einsum("bsd,df->bsf", x, w1) + b1
        zero = torch.zeros_like(h)
        r = torch.where(h > zero, h, zero)
        h = r * r
        out = torch.einsum("bsf,fd->bsd", h, w2) + b2
        return out

    x = A_x
    xn = _layernorm(x, axis=-1)
    return x + _A_ref(xn, A_wqkv, A_w_phi, A_wo) + _B_ref(xn, B_w1, B_b1, B_w2, B_b2)
```

```asm
; @launch grid=(256,1,1) block=(512,1,1) lds=163840
.amdgcn_target "amdgcn-amd-amdhsa--gfx950"
.text
.globl parallel_sum__linear_kernel_hedgehog__dense_activation_squared_relu__prompt_kernel
.p2align 8
.type parallel_sum__linear_kernel_hedgehog__dense_activation_squared_relu__prompt_kernel,@function
parallel_sum__linear_kernel_hedgehog__dense_activation_squared_relu__prompt_kernel:
    s_cmp_ge_u32 s2, 256
    s_cbranch_scc1 parallel_sum__linear_kernel_hedgehog__dense_activation_squared_relu__prompt_kernel_done
    s_load_dwordx2 s[8:9], s[0:1], 0
    s_load_dwordx2 s[68:69], s[0:1], 8
    s_load_dwordx2 s[60:61], s[0:1], 16
    s_load_dwordx2 s[64:65], s[0:1], 24
    s_load_dwordx2 s[12:13], s[0:1], 40
    s_load_dwordx2 s[58:59], s[0:1], 48
    s_load_dwordx2 s[62:63], s[0:1], 56
    s_load_dwordx2 s[70:71], s[0:1], 64
    s_load_dwordx2 s[72:73], s[0:1], 72
    s_load_dwordx2 s[24:25], s[0:1], 80
    s_load_dwordx2 s[66:67], s[0:1], 88
    v_lshrrev_b32 v2, 6, v0
    v_and_b32 v1, 63, v0
    v_readfirstlane_b32 s40, v2
    s_and_b32 s52, s2, 7
    s_lshr_b32 s53, s2, 3
    s_lshr_b32 s43, s52, 2
    s_lshl_b32 s43, s43, 3
    s_lshr_b32 s54, s53, 2
    s_add_u32 s43, s43, s54
    s_and_b32 s44, s52, 3
    s_lshl_b32 s44, s44, 2
    s_and_b32 s54, s53, 3
    s_add_u32 s44, s44, s54
    s_and_b32 s41, s40, 3
    s_lshr_b32 s42, s40, 2
    s_lshl_b32 s46, s44, 1
    s_add_u32 s54, s44, 11
    s_cmp_lt_u32 s44, 11
    s_cselect_b32 s46, s46, s54
    s_cselect_b32 s45, 2, 1
    s_lshl_b32 s51, s40, 10
    v_lshlrev_b32 v74, 4, v1
    v_lshrrev_b32 v6, 5, v1
    v_mov_b32 v94, 0
    v_mul_u32_u24 v2, 0x1112, v1
    v_lshrrev_b32 v2, 16, v2
    v_mul_u32_u24 v3, 15, v2
    v_sub_u32 v3, v1, v3
    v_mul_u32_u24 v4, 0x3334, v3
    v_lshrrev_b32 v4, 16, v4
    v_mul_u32_u24 v5, 5, v4
    v_sub_u32 v5, v3, v5
    v_mul_u32_u24 v8, 15360, v2
    v_lshlrev_b32 v5, 4, v5
    v_add_u32 v8, v8, v5
    v_add_u32 v4, 1, v4
    v_mul_u32_u24 v5, 1280, v4
    v_cmp_eq_u32 vcc, 3, v4
    s_nop 1
    v_cndmask_b32 v5, v5, 0, vcc
    v_add_u32 v8, v8, v5
    v_lshrrev_b32 v2, 3, v1
    v_and_b32 v4, 7, v1
    v_mul_u32_u24 v73, 3456, v2
    v_lshrrev_b32 v3, 4, v1
    v_and_b32 v3, 1, v3
    v_lshlrev_b32 v3, 2, v3
    v_xor_b32 v3, v3, v4
    v_lshlrev_b32 v3, 4, v3
    v_add_u32 v73, v73, v3
    v_mul_u32_u24 v14, 1280, v2
    v_lshl_add_u32 v14, v4, 4, v14
    v_mul_u32_u24 v72, 1280, v2
    v_lshrrev_b32 v3, 4, v1
    s_and_b32 s54, s40, 1
    s_lshl_b32 s54, s54, 2
    v_add_u32 v3, s54, v3
    v_xor_b32 v3, v3, v4
    v_lshlrev_b32 v3, 4, v3
    v_add_u32 v72, v72, v3
    s_sub_u32 s52, 4, s41
    s_and_b32 s52, s52, 3
    s_lshl_b32 s53, s42, 4
    s_add_u32 s53, s53, s43
    s_lshl_b32 s53, s53, 4
    s_add_u32 s52, s52, s53
    s_mul_i32 s85, s52, 3840
    s_mul_i32 s52, s44, 80
    s_add_u32 s85, s85, s52
    s_mul_i32 s53, s41, 960
    s_mul_i32 s54, s42, 3840
    s_add_u32 s53, s53, s54
    s_lshl_b32 s54, s43, 7
    s_lshl_b32 s55, s40, 3
    s_add_u32 s54, s54, s55
    s_mul_i32 s47, s54, 1280
    s_add_u32 s48, s47, 81920
    s_mul_i32 s49, s55, 3456
    s_lshl_b32 s54, s46, 7
    s_add_u32 s49, s49, s54
    s_waitcnt lgkmcnt(0)
    s_mov_b32 s28, s68
    s_mov_b32 s29, s69
    s_mov_b32 s30, 2457600
    s_mov_b32 s31, 0x20000
    s_mov_b32 s10, 2621440
    s_mov_b32 s11, 0x20000
    s_mov_b32 s14, 2211840
    s_mov_b32 s15, 0x20000
    s_add_u32 m0, s51, 32768
    s_nop 0
    buffer_load_dwordx4 v72, s[8:11], s47 offen lds
    s_add_u32 m0, s51, 40960
    s_nop 0
    buffer_load_dwordx4 v72, s[8:11], s48 offen lds
    s_add_u32 s47, s47, 128
    s_add_u32 s48, s48, 128
    s_add_u32 m0, s51, 49152
    s_nop 0
    buffer_load_dwordx4 v73, s[12:15], s49 offen lds
    s_cmp_eq_u32 s45, 1
    s_cbranch_scc1 parallel_sum__linear_kernel_hedgehog__dense_activation_squared_relu__prompt_kernel_o_1
    s_add_u32 m0, s51, 57216
    s_nop 0
    buffer_load_dwordx4 v73, s[12:15], s49 offen offset:128 lds
parallel_sum__linear_kernel_hedgehog__dense_activation_squared_relu__prompt_kernel_o_1:
    s_add_u32 s49, s49, 221184
    s_mov_b32 exec_hi, 0x0fffffff
    s_add_u32 m0, s53, 131072
    s_nop 0
    buffer_load_dwordx4 v8, s[28:31], s85 offen lds
    s_cmp_ge_u32 s43, 8
    s_cbranch_scc1 parallel_sum__linear_kernel_hedgehog__dense_activation_squared_relu__prompt_kernel_o_2
    s_cmp_ge_u32 s40, 4
    s_cbranch_scc1 parallel_sum__linear_kernel_hedgehog__dense_activation_squared_relu__prompt_kernel_o_3
    s_add_u32 s85, s85, 1966080
    s_add_u32 m0, s53, 138752
    s_nop 0
    buffer_load_dwordx4 v8, s[28:31], s85 offen lds
parallel_sum__linear_kernel_hedgehog__dense_activation_squared_relu__prompt_kernel_o_3:
parallel_sum__linear_kernel_hedgehog__dense_activation_squared_relu__prompt_kernel_o_2:
    s_mov_b32 exec_hi, -1
    s_lshr_b32 s52, s40, 1
    s_and_b32 s52, s52, 1
    s_and_b32 s53, s40, 1
    s_lshl_b32 s54, s42, 4
    s_add_u32 s54, s54, s43
    s_lshl_b32 s54, s54, 4
    s_lshl_b32 s55, s53, 3
    s_add_u32 s54, s54, s55
    s_mul_i32 s86, s54, 3456
    s_add_u32 s54, s46, s52
    s_lshl_b32 s54, s54, 7
    s_add_u32 s86, s86, s54
    s_lshl_b32 s54, s42, 12
    s_lshl_b32 s55, s52, 11
    s_add_u32 s54, s54, s55
    s_lshl_b32 s55, s53, 10
    s_add_u32 s54, s54, s55
    s_cmp_ge_u32 s52, s45
    s_cbranch_scc1 parallel_sum__linear_kernel_hedgehog__dense_activation_squared_relu__prompt_kernel_o_4
    s_add_u32 m0, s54, 143360
    s_nop 0
    buffer_load_dwordx4 v73, s[12:15], s86 offen lds
    s_cmp_ge_u32 s43, 8
    s_cbranch_scc1 parallel_sum__linear_kernel_hedgehog__dense_activation_squared_relu__prompt_kernel_o_5
    s_cmp_ge_u32 s40, 4
    s_cbranch_scc1 parallel_sum__linear_kernel_hedgehog__dense_activation_squared_relu__prompt_kernel_o_6
    s_add_u32 s86, s86, 1769472
    s_add_u32 m0, s54, 151552
    s_nop 0
    buffer_load_dwordx4 v73, s[12:15], s86 offen lds
parallel_sum__linear_kernel_hedgehog__dense_activation_squared_relu__prompt_kernel_o_6:
parallel_sum__linear_kernel_hedgehog__dense_activation_squared_relu__prompt_kernel_o_5:
parallel_sum__linear_kernel_hedgehog__dense_activation_squared_relu__prompt_kernel_o_4:
    s_cmp_lg_u32 s40, 3
    s_cbranch_scc1 parallel_sum__linear_kernel_hedgehog__dense_activation_squared_relu__prompt_kernel_o_7
    s_lshl_b32 s54, s43, 7
    s_lshl_b32 s55, s44, 3
    s_add_u32 s54, s54, s55
    s_mul_i32 s54, s54, 1280
    buffer_load_dwordx4 a[120:123], v14, s[8:11], s54 offen offset:0
    buffer_load_dwordx4 a[124:127], v14, s[8:11], s54 offen offset:128
    buffer_load_dwordx4 a[128:131], v14, s[8:11], s54 offen offset:256
    buffer_load_dwordx4 a[132:135], v14, s[8:11], s54 offen offset:384
    buffer_load_dwordx4 a[136:139], v14, s[8:11], s54 offen offset:512
    buffer_load_dwordx4 a[140:143], v14, s[8:11], s54 offen offset:640
    buffer_load_dwordx4 a[144:147], v14, s[8:11], s54 offen offset:768
    buffer_load_dwordx4 a[148:151], v14, s[8:11], s54 offen offset:896
    buffer_load_dwordx4 a[152:155], v14, s[8:11], s54 offen offset:1024
    buffer_load_dwordx4 a[156:159], v14, s[8:11], s54 offen offset:1152
parallel_sum__linear_kernel_hedgehog__dense_activation_squared_relu__prompt_kernel_o_7:
    s_mov_b32 s16, s66
    s_mov_b32 s17, s67
    s_mov_b32 s18, 9699328
    s_mov_b32 s19, 0x20000
    s_add_u32 s20, s66, 13631488
    s_addc_u32 s21, s67, 0
    s_mov_b32 s22, 1720320
    s_mov_b32 s23, 0x20000
    s_mov_b32 s26, 256
    s_mov_b32 s27, 0x20000
    s_add_u32 s32, s66, 15466496
    s_addc_u32 s33, s67, 0
    s_mov_b32 s34, 65536
    s_mov_b32 s35, 0x20000
    s_add_u32 s36, s66, 15728640
    s_addc_u32 s37, s67, 0
    s_mov_b32 s38, 3473408
    s_mov_b32 s39, 0x20000
    s_mul_i32 s50, s44, 163840
    s_add_u32 s50, s50, s51
    s_cmp_eq_u32 s45, 1
    s_cbranch_scc1 parallel_sum__linear_kernel_hedgehog__dense_activation_squared_relu__prompt_kernel_nl1
    s_or_b32 s54, s2, s40
    s_cmp_lg_u32 s54, 0
    s_cbranch_scc1 parallel_sum__linear_kernel_hedgehog__dense_activation_squared_relu__prompt_kernel_o_8
    s_memrealtime s[54:55]
    s_waitcnt lgkmcnt(0)
    s_or_b32 s54, s54, 1
    v_mov_b32 v3, s54
    v_mov_b32 v2, 0
    buffer_store_dword v3, v2, s[24:27], 0 offen sc1
parallel_sum__linear_kernel_hedgehog__dense_activation_squared_relu__prompt_kernel_o_8:
    s_add_u32 m0, s51, 65536
    s_nop 0
    buffer_load_dwordx4 v72, s[8:11], s47 offen lds
    s_add_u32 m0, s51, 73728
    s_nop 0
    buffer_load_dwordx4 v72, s[8:11], s48 offen lds
    s_add_u32 s47, s47, 128
    s_add_u32 s48, s48, 128
    s_add_u32 m0, s51, 81920
    s_nop 0
    buffer_load_dwordx4 v73, s[12:15], s49 offen offset:0 lds
    s_add_u32 m0, s51, 89984
    s_nop 0
    buffer_load_dwordx4 v73, s[12:15], s49 offen offset:128 lds
    s_add_u32 s49, s49, 221184
    s_cmp_lg_u32 s40, 0
    s_cbranch_scc1 parallel_sum__linear_kernel_hedgehog__dense_activation_squared_relu__prompt_kernel_o_9
    v_mov_b32 v94, 0
    buffer_load_dword v95, v94, s[24:27], 0 offen sc1
parallel_sum__linear_kernel_hedgehog__dense_activation_squared_relu__prompt_kernel_o_9:
    s_add_u32 m0, s51, 98304
    s_nop 0
    buffer_load_dwordx4 v72, s[8:11], s47 offen lds
    s_add_u32 m0, s51, 106496
    s_nop 0
    buffer_load_dwordx4 v72, s[8:11], s48 offen lds
    s_add_u32 s47, s47, 128
    s_add_u32 s48, s48, 128
    s_add_u32 m0, s51, 114688
    s_nop 0
    buffer_load_dwordx4 v73, s[12:15], s49 offen offset:0 lds
    s_add_u32 m0, s51, 122752
    s_nop 0
    buffer_load_dwordx4 v73, s[12:15], s49 offen offset:128 lds
    s_add_u32 s49, s49, 221184
    s_cmp_lg_u32 s40, 2
    s_cbranch_scc1 parallel_sum__linear_kernel_hedgehog__dense_activation_squared_relu__prompt_kernel_o_10
    s_mov_b32 s28, s58
    s_mov_b32 s29, s59
    s_mov_b32 s30, 3456
    s_lshl_b32 s54, s46, 7
    v_lshlrev_b32 v2, 2, v1
    s_mov_b32 m0, 0
    s_nop 0
    buffer_load_dword v2, s[28:31], s54 offen lds
parallel_sum__linear_kernel_hedgehog__dense_activation_squared_relu__prompt_kernel_o_10:
    s_cmp_ge_u32 s40, 2
    s_cbranch_scc1 parallel_sum__linear_kernel_hedgehog__dense_activation_squared_relu__prompt_kernel_o_11
    s_mov_b32 s28, s60
    s_mov_b32 s29, s61
    s_mov_b32 s30, 25600
    s_mul_i32 s54, s44, 1600
    s_add_u32 s54, s54, s51
    s_add_u32 m0, s51, 5120
    s_nop 0
    buffer_load_dwordx4 v74, s[28:31], s54 offen lds
parallel_sum__linear_kernel_hedgehog__dense_activation_squared_relu__prompt_kernel_o_11:
    v_and_b32 v2, 31, v1
    v_lshrrev_b32 v4, 1, v2
    v_and_b32 v4, 7, v4
    v_xor_b32 v4, v4, v6
    v_lshlrev_b32 v4, 4, v4
    s_lshl_b32 s54, s41, 12
    v_lshlrev_b32 v5, 7, v2
    v_add_u32 v5, s54, v5
    v_add_u32 v76, v5, v4
    v_xor_b32 v77, 32, v76
    v_xor_b32 v78, 64, v76
    v_xor_b32 v79, 96, v76
    v_bfe_u32 v11, v1, 2, 2
    v_bfe_u32 v2, v1, 4, 1
    v_and_b32 v3, 3, v1
    v_lshl_add_u32 v12, v2, 2, v3
    v_cmp_eq_u32 s[74:75], 1, v3
    v_cmp_eq_u32 s[76:77], 2, v3
    v_cmp_eq_u32 s[78:79], 3, v3
    v_cmp_lt_u32 s[80:81], 31, v1
    s_mov_b32 s87, 0xffff
    v_lshl_add_u32 v2, v6, 3, v11
    v_lshlrev_b32 v75, 7, v2
    v_lshrrev_b32 v3, 1, v12
    s_lshl_b32 s54, s42, 2
    v_add_u32 v3, s54, v3
    v_bfe_u32 v4, v11, 1, 1
    v_lshlrev_b32 v4, 2, v4
    v_xor_b32 v3, v3, v4
    v_lshl_add_u32 v75, v3, 4, v75
    v_and_b32 v3, 1, v12
    v_lshl_add_u32 v75, v3, 3, v75
    s_lshl_b32 s54, s41, 12
    v_add_u32 v13, s54, v75
    v_sub_u32 v2, 4, v11
    v_and_b32 v2, 3, v2
    v_lshlrev_b32 v2, 2, v2
    v_lshl_add_u32 v2, v6, 1, v2
    v_mul_u32_u24 v2, 240, v2
    s_mul_i32 s54, s42, 40
    s_mul_i32 s55, s41, 3840
    s_add_u32 s54, s54, s55
    v_add_u32 v2, s54, v2
    v_lshrrev_b32 v3, 1, v12
    v_and_b32 v4, 1, v12
    v_mul_u32_u24 v5, 160, v4
    v_lshl_add_u32 v5, v3, 3, v5
    v_add_u32 v9, v2, v5
    s_mov_b32 s54, 131072
    v_add_u32 v9, s54, v9
    v_add_u32 v2, s54, v2
    s_mov_b32 s54, 143360
    v_add_u32 v13, s54, v13
    v_mov_b32 v3, 0x6850c020
    v_mov_b32 v4, 0x50607058
    v_cmp_gt_u32 vcc, 4, v12
    s_nop 1
    v_cndmask_b32 v3, v4, v3, vcc
    v_and_b32 v4, 3, v12
    v_lshlrev_b32 v4, 3, v4
    v_lshrrev_b32 v3, v4, v3
    v_and_b32 v3, 0xff, v3
    v_add_u32 v10, v2, v3
    v_mov_b32 v92, 0x3f803f80
    v_mov_b32 v93, 0x3f803f80
    v_mov_b32 v80, 0
    v_mov_b32 v81, 0
    v_mov_b32 v82, 0
    v_mov_b32 v83, 0
    ds_write_b128 v74, v[80:83] offset:512
    ds_write_b128 v74, v[80:83] offset:1536
    ds_write_b128 v74, v[80:83] offset:2560
    ds_write_b128 v74, v[80:83] offset:7168
    v_lshlrev_b32 v2, 2, v1
    v_mov_b32 v3, 0
    ds_write_b32 v2, v3 offset:256
    s_waitcnt vmcnt(8)
    s_waitcnt lgkmcnt(0)
    s_barrier
    s_lshl_b32 s54, s41, 4
    s_add_u32 s54, s54, s43
    s_cmp_ge_u32 s54, 40
    s_cbranch_scc1 parallel_sum__linear_kernel_hedgehog__dense_activation_squared_relu__prompt_kernel_o_12
    ds_read_b64_tr_b16 v[40:41], v9 offset:0
    ds_read_b64_tr_b16 v[42:43], v9 offset:240
    ds_read_b64_tr_b16 v[44:45], v10 offset:0
    ds_read_b64_tr_b16 v[46:47], v10 offset:240
    ds_read_b64_tr_b16 v[48:49], v13 offset:0
    ds_read_b64_tr_b16 v[50:51], v13 offset:512
    ds_read_b64_tr_b16 v[52:53], v13 offset:2048
    ds_read_b64_tr_b16 v[54:55], v13 offset:2560
    s_mul_i32 s55, s44, 40
    s_add_u32 s54, s54, s55
    s_lshl_b32 s54, s54, 12
    s_lshl_b32 s55, s42, 11
    s_add_u32 s54, s54, s55
    s_waitcnt lgkmcnt(4)
    buffer_store_dwordx4 v[40:43], v74, s[36:39], s54 offen offset:0 sc1
    buffer_store_dwordx4 v[44:47], v74, s[36:39], s54 offen offset:1024 sc1
    s_waitcnt lgkmcnt(0)
    v_mfma_f32_4x4x4_16b_bf16 v[56:59], v[40:41], v[92:93], 0
    v_mfma_f32_4x4x4_16b_bf16 v[60:63], v[44:45], v[92:93], 0
    v_mfma_f32_4x4x4_16b_bf16 v[64:67], v[48:49], v[92:93], 0
    v_mfma_f32_4x4x4_16b_bf16 v[68:71], v[52:53], v[92:93], 0
    v_mfma_f32_4x4x4_16b_bf16 v[56:59], v[42:43], v[92:93], v[56:59]
    v_mfma_f32_4x4x4_16b_bf16 v[60:63], v[46:47], v[92:93], v[60:63]
    v_mfma_f32_4x4x4_16b_bf16 v[64:67], v[50:51], v[92:93], v[64:67]
    v_mfma_f32_4x4x4_16b_bf16 v[68:71], v[54:55], v[92:93], v[68:71]
    v_and_b32 v2, 31, v1
    v_lshlrev_b32 v2, 2, v2
    s_lshl_b32 s55, s41, 10
    s_lshl_b32 s54, s42, 7
    s_add_u32 s54, s54, s55
    v_add_u32 v3, s54, v2
    s_lshl_b32 s54, s42, 8
    s_add_u32 s54, s54, s55
    v_add_u32 v2, s54, v2
    v_cndmask_b32 v88, v56, v57, s[74:75]
    v_cndmask_b32 v88, v88, v58, s[76:77]
    v_cndmask_b32 v88, v88, v59, s[78:79]
    v_cndmask_b32 v89, v60, v61, s[74:75]
    v_cndmask_b32 v89, v89, v62, s[76:77]
    v_cndmask_b32 v89, v89, v63, s[78:79]
    v_cndmask_b32 v90, v64, v65, s[74:75]
    v_cndmask_b32 v90, v90, v66, s[76:77]
    v_cndmask_b32 v90, v90, v67, s[78:79]
    v_cndmask_b32 v91, v68, v69, s[74:75]
    v_cndmask_b32 v91, v91, v70, s[76:77]
    v_cndmask_b32 v91, v91, v71, s[78:79]
    v_mov_b32 v4, v88
    s_nop 1
    v_permlane32_swap_b32 v88, v4
    v_add_f32 v88, v88, v4
    v_mov_b32 v4, v89
    s_nop 1
    v_permlane32_swap_b32 v89, v4
    v_add_f32 v89, v89, v4
    v_mov_b32 v4, v90
    s_nop 1
    v_permlane32_swap_b32 v90, v4
    v_add_f32 v90, v90, v4
    v_mov_b32 v4, v91
    s_nop 1
    v_permlane32_swap_b32 v91, v4
    v_add_f32 v91, v91, v4
    ds_write_b32 v2, v88 offset:1024
    ds_write_b32 v2, v89 offset:1152
    ds_write_b32 v3, v90 offset:512
    ds_write_b32 v3, v91 offset:768
parallel_sum__linear_kernel_hedgehog__dense_activation_squared_relu__prompt_kernel_o_12:
    s_waitcnt lgkmcnt(0)
    s_barrier
    s_cmp_lg_u32 s40, 4
    s_cbranch_scc1 parallel_sum__linear_kernel_hedgehog__dense_activation_squared_relu__prompt_kernel_o_13
    s_nop 0
    ds_read_b128 v[56:59], v74 offset:512
    ds_read_b128 v[60:63], v74 offset:1536
    ds_read_b128 v[64:67], v74 offset:2560
    s_lshl_b32 s54, s44, 4
    s_add_u32 s54, s54, s43
    s_lshl_b32 s54, s54, 10
    s_add_u32 s54, s54, 3211264
    s_waitcnt lgkmcnt(0)
    v_add_f32 v56, v56, v60
    v_add_f32 v56, v56, v64
    v_add_f32 v57, v57, v61
    v_add_f32 v57, v57, v65
    v_add_f32 v58, v58, v62
    v_add_f32 v58, v58, v66
    v_add_f32 v59, v59, v63
    v_add_f32 v59, v59, v67
    buffer_store_dwordx4 v[56:59], v74, s[36:39], s54 offen sc1
parallel_sum__linear_kernel_hedgehog__dense_activation_squared_relu__prompt_kernel_o_13:
    s_add_u32 m0, s51, 131072
    s_nop 0
    buffer_load_dwordx4 v72, s[8:11], s47 offen lds
    s_add_u32 m0, s51, 139264
    s_nop 0
    buffer_load_dwordx4 v72, s[8:11], s48 offen lds
    s_add_u32 s47, s47, 128
    s_add_u32 s48, s48, 128
    s_add_u32 m0, s51, 147456
    s_nop 0
    buffer_load_dwordx4 v73, s[12:15], s49 offen offset:0 lds
    s_add_u32 m0, s51, 155520
    s_nop 0
    buffer_load_dwordx4 v73, s[12:15], s49 offen offset:128 lds
    s_add_u32 s49, s49, 221184
    s_waitcnt vmcnt(13)
    s_barrier
    v_add_u32 v76, 0x8000, v76
    v_add_u32 v77, 0x8000, v77
    v_add_u32 v78, 0x8000, v78
    v_add_u32 v79, 0x8000, v79
    ds_read_b128 a[0:3], v76
    ds_read_b128 a[4:7], v77
    ds_read_b128 a[8:11], v78
    ds_read_b128 a[12:15], v79
    v_add_u32 v75, 0x8000, v75
    ds_read_b64_tr_b16 v[40:41], v75 offset:16384
    ds_read_b64_tr_b16 v[42:43], v75 offset:16896
    ds_read_b64_tr_b16 v[44:45], v75 offset:24576
    ds_read_b64_tr_b16 v[46:47], v75 offset:25088
    ds_read_b64_tr_b16 v[48:49], v75 offset:18432
    ds_read_b64_tr_b16 v[50:51], v75 offset:18944
    ds_read_b64_tr_b16 v[52:53], v75 offset:26624
    ds_read_b64_tr_b16 v[54:55], v75 offset:27136
    s_waitcnt lgkmcnt(4)
    v_mfma_f32_32x32x16_bf16 v[8:23], v[40:43], a[0:3], 0
    ds_read_b64_tr_b16 v[80:81], v75 offset:20480
    ds_read_b64_tr_b16 v[82:83], v75 offset:20992
    v_mfma_f32_32x32x16_bf16 v[24:39], v[44:47], a[0:3], 0
    ds_read_b64_tr_b16 v[84:85], v75 offset:28672
    ds_read_b64_tr_b16 v[86:87], v75 offset:29184
    s_waitcnt lgkmcnt(4)
    v_mfma_f32_32x32x16_bf16 v[8:23], v[48:51], a[4:7], v[8:23]
    ds_read_b64_tr_b16 v[40:41], v75 offset:22528
    ds_read_b64_tr_b16 v[42:43], v75 offset:23040
    v_mfma_f32_32x32x16_bf16 v[24:39], v[52:55], a[4:7], v[24:39]
    ds_read_b64_tr_b16 v[44:45], v75 offset:30720
    ds_read_b64_tr_b16 v[46:47], v75 offset:31232
    s_cmp_lg_u32 s40, 3
    s_cbranch_scc1 parallel_sum__linear_kernel_hedgehog__dense_activation_squared_relu__prompt_kernel_o_14
    s_waitcnt vmcnt(12)
    v_mfma_f32_4x4x4_16b_bf16 v[64:67], a[120:121], a[120:121], 0
    v_mfma_f32_4x4x4_16b_bf16 v[56:59], a[120:121], v[92:93], 0
    v_mfma_f32_4x4x4_16b_bf16 v[68:71], a[122:123], a[122:123], 0
    v_mfma_f32_4x4x4_16b_bf16 v[60:63], a[122:123], v[92:93], 0
    v_mfma_f32_4x4x4_16b_bf16 v[64:67], a[124:125], a[124:125], v[64:67]
    v_mfma_f32_4x4x4_16b_bf16 v[56:59], a[124:125], v[92:93], v[56:59]
    v_mfma_f32_4x4x4_16b_bf16 v[68:71], a[126:127], a[126:127], v[68:71]
    v_mfma_f32_4x4x4_16b_bf16 v[60:63], a[126:127], v[92:93], v[60:63]
    v_mfma_f32_4x4x4_16b_bf16 v[64:67], a[128:129], a[128:129], v[64:67]
    v_mfma_f32_4x4x4_16b_bf16 v[56:59], a[128:129], v[92:93], v[56:59]
    v_mfma_f32_4x4x4_16b_bf16 v[68:71], a[130:131], a[130:131], v[68:71]
    v_mfma_f32_4x4x4_16b_bf16 v[60:63], a[130:131], v[92:93], v[60:63]
    v_mfma_f32_4x4x4_16b_bf16 v[64:67], a[132:133], a[132:133], v[64:67]
    v_mfma_f32_4x4x4_16b_bf16 v[56:59], a[132:133], v[92:93], v[56:59]
    v_mfma_f32_4x4x4_16b_bf16 v[68:71], a[134:135], a[134:135], v[68:71]
    v_mfma_f32_4x4x4_16b_bf16 v[60:63], a[134:135], v[92:93], v[60:63]
    v_mfma_f32_4x4x4_16b_bf16 v[64:67], a[136:137], a[136:137], v[64:67]
    v_mfma_f32_4x4x4_16b_bf16 v[56:59], a[136:137], v[92:93], v[56:59]
    v_mfma_f32_4x4x4_16b_bf16 v[68:71], a[138:139], a[138:139], v[68:71]
    v_mfma_f32_4x4x4_16b_bf16 v[60:63], a[138:139], v[92:93], v[60:63]
    v_mfma_f32_4x4x4_16b_bf16 v[64:67], a[140:141], a[140:141], v[64:67]
    v_mfma_f32_4x4x4_16b_bf16 v[56:59], a[140:141], v[92:93], v[56:59]
    v_mfma_f32_4x4x4_16b_bf16 v[68:71], a[142:143], a[142:143], v[68:71]
    v_mfma_f32_4x4x4_16b_bf16 v[60:63], a[142:143], v[92:93], v[60:63]
    v_mfma_f32_4x4x4_16b_bf16 v[64:67], a[144:145], a[144:145], v[64:67]
    v_mfma_f32_4x4x4_16b_bf16 v[56:59], a[144:145], v[92:93], v[56:59]
    v_mfma_f32_4x4x4_16b_bf16 v[68:71], a[146:147], a[146:147], v[68:71]
    v_mfma_f32_4x4x4_16b_bf16 v[60:63], a[146:147], v[92:93], v[60:63]
    v_mfma_f32_4x4x4_16b_bf16 v[64:67], a[148:149], a[148:149], v[64:67]
    v_mfma_f32_4x4x4_16b_bf16 v[56:59], a[148:149], v[92:93], v[56:59]
    v_mfma_f32_4x4x4_16b_bf16 v[68:71], a[150:151], a[150:151], v[68:71]
    v_mfma_f32_4x4x4_16b_bf16 v[60:63], a[150:151], v[92:93], v[60:63]
    v_mfma_f32_4x4x4_16b_bf16 v[64:67], a[152:153], a[152:153], v[64:67]
    v_mfma_f32_4x4x4_16b_bf16 v[56:59], a[152:153], v[92:93], v[56:59]
    v_mfma_f32_4x4x4_16b_bf16 v[68:71], a[154:155], a[154:155], v[68:71]
    v_mfma_f32_4x4x4_16b_bf16 v[60:63], a[154:155], v[92:93], v[60:63]
    v_mfma_f32_4x4x4_16b_bf16 v[64:67], a[156:157], a[156:157], v[64:67]
    v_mfma_f32_4x4x4_16b_bf16 v[56:59], a[156:157], v[92:93], v[56:59]
    v_mfma_f32_4x4x4_16b_bf16 v[68:71], a[158:159], a[158:159], v[68:71]
    v_mfma_f32_4x4x4_16b_bf16 v[60:63], a[158:159], v[92:93], v[60:63]
    s_nop 2
    v_cndmask_b32 v2, v56, v57, s[74:75]
    v_cndmask_b32 v2, v2, v58, s[76:77]
    v_cndmask_b32 v2, v2, v59, s[78:79]
    v_cndmask_b32 v3, v60, v61, s[74:75]
    v_cndmask_b32 v3, v3, v62, s[76:77]
    v_cndmask_b32 v3, v3, v63, s[78:79]
    v_cndmask_b32 v4, v64, v65, s[74:75]
    v_cndmask_b32 v4, v4, v66, s[76:77]
    v_cndmask_b32 v4, v4, v67, s[78:79]
    v_cndmask_b32 v5, v68, v69, s[74:75]
    v_cndmask_b32 v5, v5, v70, s[76:77]
    v_cndmask_b32 v5, v5, v71, s[78:79]
    v_add_f32 v2, v2, v3
    v_add_f32 v4, v4, v5
    s_nop 0
    v_add_f32_dpp v2, v2, v2 quad_perm:[1,0,3,2] row_mask:0xf bank_mask:0xf
    v_add_f32_dpp v4, v4, v4 quad_perm:[1,0,3,2] row_mask:0xf bank_mask:0xf
    s_nop 0
    v_add_f32_dpp v2, v2, v2 quad_perm:[2,3,0,1] row_mask:0xf bank_mask:0xf
    v_add_f32_dpp v4, v4, v4 quad_perm:[2,3,0,1] row_mask:0xf bank_mask:0xf
    s_nop 0
    v_add_f32_dpp v2, v2, v2 row_half_mirror row_mask:0xf bank_mask:0xf
    v_add_f32_dpp v4, v4, v4 row_half_mirror row_mask:0xf bank_mask:0xf
    v_mul_f32 v2, 0xbacccccd, v2
    v_mul_f32 v3, 0x3acccccd, v4
    v_fma_f32 v3, -v2, v2, v3
    v_max_f32 v3, 0, v3
    v_add_f32 v3, 0x3727c5ac, v3
    v_lshrrev_b32 v4, 3, v1
    s_lshl_b32 s54, s43, 7
    s_lshl_b32 s55, s44, 3
    s_add_u32 s54, s54, s55
    v_add_u32 v4, s54, v4
    v_lshlrev_b32 v4, 3, v4
    s_mov_b32 s54, 3145728
    buffer_store_dwordx2 v[2:3], v4, s[36:39], s54 offen sc1
parallel_sum__linear_kernel_hedgehog__dense_activation_squared_relu__prompt_kernel_o_14:
    s_waitcnt lgkmcnt(4)
    v_mfma_f32_32x32x16_bf16 v[8:23], v[80:83], a[8:11], v[8:23]
    v_mfma_f32_32x32x16_bf16 v[24:39], v[84:87], a[8:11], v[24:39]
    s_waitcnt lgkmcnt(0)
    s_waitcnt vmcnt(8)
    s_barrier
    v_add_u32 v76, 0x8000, v76
    v_add_u32 v77, 0x8000, v77
    v_add_u32 v78, 0x8000, v78
    v_add_u32 v79, 0x8000, v79
    ds_read_b128 a[16:19], v76
    v_add_u32 v75, 0x8000, v75
    ds_read_b64_tr_b16 v[48:49], v75 offset:16384
    ds_read_b64_tr_b16 v[50:51], v75 offset:16896
    ds_read_b64_tr_b16 v[52:53], v75 offset:24576
    ds_read_b64_tr_b16 v[54:55], v75 offset:25088
    v_mfma_f32_32x32x16_bf16 v[8:23], v[40:43], a[12:15], v[8:23]
    ds_read_b128 a[20:23], v77
    v_mfma_f32_32x32x16_bf16 v[24:39], v[44:47], a[12:15], v[24:39]
    ds_read_b64_tr_b16 v[80:81], v75 offset:18432
    ds_read_b64_tr_b16 v[82:83], v75 offset:18944
    ds_read_b64_tr_b16 v[84:85], v75 offset:26624
    ds_read_b64_tr_b16 v[86:87], v75 offset:27136
    s_add_u32 m0, s51, 32768
    s_nop 0
    buffer_load_dwordx4 v72, s[8:11], s47 offen lds
    s_waitcnt lgkmcnt(5)
    v_mfma_f32_32x32x16_bf16 v[8:23], v[48:51], a[16:19], v[8:23]
    ds_read_b128 a[24:27], v78
    ds_read_b128 a[28:31], v79
    ds_read_b64_tr_b16 v[40:41], v75 offset:20480
    ds_read_b64_tr_b16 v[42:43], v75 offset:20992
    v_mfma_f32_32x32x16_bf16 v[24:39], v[52:55], a[16:19], v[24:39]
    ds_read_b64_tr_b16 v[44:45], v75 offset:28672
    ds_read_b64_tr_b16 v[46:47], v75 offset:29184
    s_add_u32 m0, s51, 40960
    s_nop 0
    buffer_load_dwordx4 v72, s[8:11], s48 offen lds
    s_add_u32 s47, s47, 128
    s_add_u32 s48, s48, 128
    s_waitcnt lgkmcnt(6)
    v_mfma_f32_32x32x16_bf16 v[8:23], v[80:83], a[20:23], v[8:23]
    ds_read_b64_tr_b16 v[48:49], v75 offset:22528
    ds_read_b64_tr_b16 v[50:51], v75 offset:23040
    v_mfma_f32_32x32x16_bf16 v[24:39], v[84:87], a[20:23], v[24:39]
    ds_read_b64_tr_b16 v[52:53], v75 offset:30720
    ds_read_b64_tr_b16 v[54:55], v75 offset:31232
    s_add_u32 m0, s51, 49152
    s_nop 0
    buffer_load_dwordx4 v73, s[12:15], s49 offen offset:0 lds
    s_waitcnt lgkmcnt(4)
    v_mfma_f32_32x32x16_bf16 v[8:23], v[40:43], a[24:27], v[8:23]
    v_mfma_f32_32x32x16_bf16 v[24:39], v[44:47], a[24:27], v[24:39]
    s_add_u32 m0, s51, 57216
    s_nop 0
    buffer_load_dwordx4 v73, s[12:15], s49 offen offset:128 lds
    s_add_u32 s49, s49, 221184
    s_waitcnt lgkmcnt(0)
    s_waitcnt vmcnt(7)
    s_cmp_lg_u32 s40, 0
    s_cbranch_scc1 parallel_sum__linear_kernel_hedgehog__dense_activation_squared_relu__prompt_kernel_o_15
    s_waitcnt vmcnt(8)
    s_mov_b32 s52, 0x40000
parallel_sum__linear_kernel_hedgehog__dense_activation_squared_relu__prompt_kernel_sp_16:
    v_cmp_eq_u32 vcc, 0, v95
    s_nop 4
    s_cbranch_vccz parallel_sum__linear_kernel_hedgehog__dense_activation_squared_relu__prompt_kernel_sd_17
    s_sub_u32 s52, s52, 1
    s_cmp_eq_u32 s52, 0
    s_cbranch_scc1 parallel_sum__linear_kernel_hedgehog__dense_activation_squared_relu__prompt_kernel_sd_17
    s_sleep 8
    buffer_load_dword v95, v94, s[24:27], 0 offen sc1
    s_waitcnt vmcnt(0)
    s_branch parallel_sum__linear_kernel_hedgehog__dense_activation_squared_relu__prompt_kernel_sp_16
parallel_sum__linear_kernel_hedgehog__dense_activation_squared_relu__prompt_kernel_sd_17:
    v_mov_b32 v2, 256
    v_readfirstlane_b32 s82, v95
    ds_write_b32 v2, v95
    s_waitcnt lgkmcnt(0)
parallel_sum__linear_kernel_hedgehog__dense_activation_squared_relu__prompt_kernel_o_15:
    s_waitcnt vmcnt(8)
    s_barrier
    v_add_u32 v76, 0x8000, v76
    v_add_u32 v77, 0x8000, v77
    v_add_u32 v78, 0x8000, v78
    v_add_u32 v79, 0x8000, v79
    ds_read_b128 a[32:35], v76
    v_add_u32 v75, 0x8000, v75
    ds_read_b64_tr_b16 v[80:81], v75 offset:16384
    ds_read_b64_tr_b16 v[82:83], v75 offset:16896
    ds_read_b64_tr_b16 v[84:85], v75 offset:24576
    ds_read_b64_tr_b16 v[86:87], v75 offset:25088
    v_mfma_f32_32x32x16_bf16 v[8:23], v[48:51], a[28:31], v[8:23]
    ds_read_b128 a[36:39], v77
    v_mfma_f32_32x32x16_bf16 v[24:39], v[52:55], a[28:31], v[24:39]
    ds_read_b64_tr_b16 v[40:41], v75 offset:18432
    ds_read_b64_tr_b16 v[42:43], v75 offset:18944
    ds_read_b64_tr_b16 v[44:45], v75 offset:26624
    ds_read_b64_tr_b16 v[46:47], v75 offset:27136
    s_add_u32 m0, s51, 65536
    s_nop 0
    buffer_load_dwordx4 v72, s[8:11], s47 offen lds
    s_cmp_lg_u32 s40, 0
    s_cbranch_scc1 parallel_sum__linear_kernel_hedgehog__dense_activation_squared_relu__prompt_kernel_o_18
    s_lshl_b32 s54, s44, 7
    s_lshl_b32 s55, s43, 2
    s_add_u32 s54, s54, s55
    s_add_u32 s54, s54, 0
    v_mov_b32 v2, s54
    v_mov_b32 v3, s82
    buffer_store_dword v3, v2, s[32:35], 0 offen sc1
parallel_sum__linear_kernel_hedgehog__dense_activation_squared_relu__prompt_kernel_o_18:
    s_waitcnt lgkmcnt(5)
    v_mfma_f32_32x32x16_bf16 v[8:23], v[80:83], a[32:35], v[8:23]
    ds_read_b128 a[40:43], v78
    ds_read_b128 a[44:47], v79
    ds_read_b64_tr_b16 v[48:49], v75 offset:20480
    ds_read_b64_tr_b16 v[50:51], v75 offset:20992
    v_mfma_f32_32x32x16_bf16 v[24:39], v[84:87], a[32:35], v[24:39]
    ds_read_b64_tr_b16 v[52:53], v75 offset:28672
    ds_read_b64_tr_b16 v[54:55], v75 offset:29184
    s_add_u32 m0, s51, 73728
    s_nop 0
    buffer_load_dwordx4 v72, s[8:11], s48 offen lds
    s_add_u32 s47, s47, 128
    s_add_u32 s48, s48, 128
    v_mov_b32 v2, 256
    ds_read_b32 v3, v2
    s_waitcnt lgkmcnt(0)
    v_readfirstlane_b32 s82, v3
    s_waitcnt lgkmcnt(7)
    v_mfma_f32_32x32x16_bf16 v[8:23], v[40:43], a[36:39], v[8:23]
    ds_read_b64_tr_b16 v[80:81], v75 offset:22528
    ds_read_b64_tr_b16 v[82:83], v75 offset:23040
    v_mfma_f32_32x32x16_bf16 v[24:39], v[44:47], a[36:39], v[24:39]
    ds_read_b64_tr_b16 v[84:85], v75 offset:30720
    ds_read_b64_tr_b16 v[86:87], v75 offset:31232
    s_add_u32 m0, s51, 81920
    s_nop 0
    buffer_load_dwordx4 v73, s[12:15], s49 offen offset:0 lds
    s_waitcnt lgkmcnt(5)
    v_mfma_f32_32x32x16_bf16 v[8:23], v[48:51], a[40:43], v[8:23]
    v_mfma_f32_32x32x16_bf16 v[24:39], v[52:55], a[40:43], v[24:39]
    s_add_u32 m0, s51, 89984
    s_nop 0
    buffer_load_dwordx4 v73, s[12:15], s49 offen offset:128 lds
    s_add_u32 s49, s49, 221184
    s_waitcnt lgkmcnt(0)
    s_cmp_lg_u32 s40, 3
    s_cbranch_scc1 parallel_sum__linear_kernel_hedgehog__dense_activation_squared_relu__prompt_kernel_o_19
    s_waitcnt vmcnt(8)
parallel_sum__linear_kernel_hedgehog__dense_activation_squared_relu__prompt_kernel_o_19:
    s_waitcnt vmcnt(8)
    s_barrier
    v_add_u32 v76, 0x8000, v76
    v_add_u32 v77, 0x8000, v77
    v_add_u32 v78, 0x8000, v78
    v_add_u32 v79, 0x8000, v79
    ds_read_b128 a[48:51], v76
    v_add_u32 v75, 0x8000, v75
    ds_read_b64_tr_b16 v[40:41], v75 offset:16384
    ds_read_b64_tr_b16 v[42:43], v75 offset:16896
    ds_read_b64_tr_b16 v[44:45], v75 offset:24576
    ds_read_b64_tr_b16 v[46:47], v75 offset:25088
    v_mfma_f32_32x32x16_bf16 v[8:23], v[80:83], a[44:47], v[8:23]
    ds_read_b128 a[52:55], v77
    v_mfma_f32_32x32x16_bf16 v[24:39], v[84:87], a[44:47], v[24:39]
    ds_read_b64_tr_b16 v[48:49], v75 offset:18432
    ds_read_b64_tr_b16 v[50:51], v75 offset:18944
    ds_read_b64_tr_b16 v[52:53], v75 offset:26624
    ds_read_b64_tr_b16 v[54:55], v75 offset:27136
    s_add_u32 m0, s51, 98304
    s_nop 0
    buffer_load_dwordx4 v72, s[8:11], s47 offen lds
    s_cmp_lg_u32 s40, 0
    s_cbranch_scc1 parallel_sum__linear_kernel_hedgehog__dense_activation_squared_relu__prompt_kernel_o_20
    s_lshl_b32 s54, s43, 7
    s_lshl_b32 s55, s44, 2
    s_add_u32 s54, s54, s55
    s_add_u32 s54, s54, 2048
    v_mov_b32 v2, s54
    v_mov_b32 v3, s82
    buffer_store_dword v3, v2, s[32:35], 0 offen sc1
parallel_sum__linear_kernel_hedgehog__dense_activation_squared_relu__prompt_kernel_o_20:
    s_waitcnt lgkmcnt(5)
    v_mfma_f32_32x32x16_bf16 v[8:23], v[40:43], a[48:51], v[8:23]
    ds_read_b128 a[56:59], v78
    ds_read_b128 a[60:63], v79
    ds_read_b64_tr_b16 v[80:81], v75 offset:20480
    ds_read_b64_tr_b16 v[82:83], v75 offset:20992
    v_mfma_f32_32x32x16_bf16 v[24:39], v[44:47], a[48:51], v[24:39]
    ds_read_b64_tr_b16 v[84:85], v75 offset:28672
    ds_read_b64_tr_b16 v[86:87], v75 offset:29184
    s_add_u32 m0, s51, 106496
    s_nop 0
    buffer_load_dwordx4 v72, s[8:11], s48 offen lds
    s_add_u32 s47, s47, 128
    s_add_u32 s48, s48, 128
    s_waitcnt lgkmcnt(6)
    v_mfma_f32_32x32x16_bf16 v[8:23], v[48:51], a[52:55], v[8:23]
    ds_read_b64_tr_b16 v[40:41], v75 offset:22528
    ds_read_b64_tr_b16 v[42:43], v75 offset:23040
    v_mfma_f32_32x32x16_bf16 v[24:39], v[52:55], a[52:55], v[24:39]
    ds_read_b64_tr_b16 v[44:45], v75 offset:30720
    ds_read_b64_tr_b16 v[46:47], v75 offset:31232
    s_add_u32 m0, s51, 114688
    s_nop 0
    buffer_load_dwordx4 v73, s[12:15], s49 offen offset:0 lds
    s_waitcnt lgkmcnt(4)
    v_mfma_f32_32x32x16_bf16 v[8:23], v[80:83], a[56:59], v[8:23]
    v_mfma_f32_32x32x16_bf16 v[24:39], v[84:87], a[56:59], v[24:39]
    s_add_u32 m0, s51, 122752
    s_nop 0
    buffer_load_dwordx4 v73, s[12:15], s49 offen offset:128 lds
    s_add_u32 s49, s49, 221184
    s_waitcnt lgkmcnt(0)
    s_waitcnt vmcnt(8)
    s_barrier
    v_subrev_u32 v76, 0x18000, v76
    v_subrev_u32 v77, 0x18000, v77
    v_subrev_u32 v78, 0x18000, v78
    v_subrev_u32 v79, 0x18000, v79
    ds_read_b128 a[64:67], v76
    v_subrev_u32 v75, 0x18000, v75
    ds_read_b64_tr_b16 v[48:49], v75 offset:16384
    ds_read_b64_tr_b16 v[50:51], v75 offset:16896
    ds_read_b64_tr_b16 v[52:53], v75 offset:24576
    ds_read_b64_tr_b16 v[54:55], v75 offset:25088
    v_mfma_f32_32x32x16_bf16 v[8:23], v[40:43], a[60:63], v[8:23]
    ds_read_b128 a[68:71], v77
    v_mfma_f32_32x32x16_bf16 v[24:39], v[44:47], a[60:63], v[24:39]
    ds_read_b64_tr_b16 v[80:81], v75 offset:18432
    ds_read_b64_tr_b16 v[82:83], v75 offset:18944
    ds_read_b64_tr_b16 v[84:85], v75 offset:26624
    ds_read_b64_tr_b16 v[86:87], v75 offset:27136
    s_add_u32 m0, s51, 131072
    s_nop 0
    buffer_load_dwordx4 v72, s[8:11], s47 offen lds
    s_waitcnt lgkmcnt(5)
    v_mfma_f32_32x32x16_bf16 v[8:23], v[48:51], a[64:67], v[8:23]
    ds_read_b128 a[72:75], v78
    ds_read_b128 a[76:79], v79
    ds_read_b64_tr_b16 v[40:41], v75 offset:20480
    ds_read_b64_tr_b16 v[42:43], v75 offset:20992
    v_mfma_f32_32x32x16_bf16 v[24:39], v[52:55], a[64:67], v[24:39]
    ds_read_b64_tr_b16 v[44:45], v75 offset:28672
    ds_read_b64_tr_b16 v[46:47], v75 offset:29184
    s_add_u32 m0, s51, 139264
    s_nop 0
    buffer_load_dwordx4 v72, s[8:11], s48 offen lds
    s_add_u32 s47, s47, 128
    s_add_u32 s48, s48, 128
    s_waitcnt lgkmcnt(6)
    v_mfma_f32_32x32x16_bf16 v[8:23], v[80:83], a[68:71], v[8:23]
    ds_read_b64_tr_b16 v[48:49], v75 offset:22528
    ds_read_b64_tr_b16 v[50:51], v75 offset:23040
    v_mfma_f32_32x32x16_bf16 v[24:39], v[84:87], a[68:71], v[24:39]
    ds_read_b64_tr_b16 v[52:53], v75 offset:30720
    ds_read_b64_tr_b16 v[54:55], v75 offset:31232
    s_add_u32 m0, s51, 147456
    s_nop 0
    buffer_load_dwordx4 v73, s[12:15], s49 offen offset:0 lds
    s_waitcnt lgkmcnt(4)
    v_mfma_f32_32x32x16_bf16 v[8:23], v[40:43], a[72:75], v[8:23]
    v_mfma_f32_32x32x16_bf16 v[24:39], v[44:47], a[72:75], v[24:39]
    s_add_u32 m0, s51, 155520
    s_nop 0
    buffer_load_dwordx4 v73, s[12:15], s49 offen offset:128 lds
    s_add_u32 s49, s49, 221184
    s_waitcnt lgkmcnt(0)
    s_waitcnt vmcnt(8)
    s_barrier
    v_add_u32 v76, 0x8000, v76
    v_add_u32 v77, 0x8000, v77
    v_add_u32 v78, 0x8000, v78
    v_add_u32 v79, 0x8000, v79
    ds_read_b128 a[80:83], v76
    v_add_u32 v75, 0x8000, v75
    ds_read_b64_tr_b16 v[80:81], v75 offset:16384
    ds_read_b64_tr_b16 v[82:83], v75 offset:16896
    ds_read_b64_tr_b16 v[84:85], v75 offset:24576
    ds_read_b64_tr_b16 v[86:87], v75 offset:25088
    v_mfma_f32_32x32x16_bf16 v[8:23], v[48:51], a[76:79], v[8:23]
    ds_read_b128 a[84:87], v77
    v_mfma_f32_32x32x16_bf16 v[24:39], v[52:55], a[76:79], v[24:39]
    ds_read_b64_tr_b16 v[40:41], v75 offset:18432
    ds_read_b64_tr_b16 v[42:43], v75 offset:18944
    ds_read_b64_tr_b16 v[44:45], v75 offset:26624
    ds_read_b64_tr_b16 v[46:47], v75 offset:27136
    s_add_u32 m0, s51, 32768
    s_nop 0
    buffer_load_dwordx4 v72, s[8:11], s47 offen lds
    s_cmp_lg_u32 s40, 0
    s_cbranch_scc1 parallel_sum__linear_kernel_hedgehog__dense_activation_squared_relu__prompt_kernel_o_21
    s_lshl_b32 s54, s2, 2
    s_add_u32 s54, s54, 4096
    v_mov_b32 v2, s54
    v_mov_b32 v3, s82
    buffer_store_dword v3, v2, s[32:35], 0 offen sc1
parallel_sum__linear_kernel_hedgehog__dense_activation_squared_relu__prompt_kernel_o_21:
    s_waitcnt lgkmcnt(5)
    v_mfma_f32_32x32x16_bf16 v[8:23], v[80:83], a[80:83], v[8:23]
    ds_read_b128 a[88:91], v78
    ds_read_b128 a[92:95], v79
    ds_read_b64_tr_b16 v[48:49], v75 offset:20480
    ds_read_b64_tr_b16 v[50:51], v75 offset:20992
    v_mfma_f32_32x32x16_bf16 v[24:39], v[84:87], a[80:83], v[24:39]
    ds_read_b64_tr_b16 v[52:53], v75 offset:28672
    ds_read_b64_tr_b16 v[54:55], v75 offset:29184
    s_add_u32 m0, s51, 40960
    s_nop 0
    buffer_load_dwordx4 v72, s[8:11], s48 offen lds
    s_add_u32 s47, s47, 128
    s_add_u32 s48, s48, 128
    v_and_b32 v2, 15, v1
    v_lshlrev_b32 v2, 2, v2
    s_lshl_b32 s54, s44, 7
    s_add_u32 s54, s54, 0
    s_lshl_b32 s55, s43, 7
    s_add_u32 s55, s55, 2048
    v_add_u32 v3, s54, v2
    v_add_u32 v2, s55, v2
    v_and_b32 v4, 16, v1
    v_cmp_eq_u32 vcc, 0, v4
    s_nop 1
    v_cndmask_b32 v88, v2, v3, vcc
    s_cmp_lg_u32 s40, 0
    s_cbranch_scc1 parallel_sum__linear_kernel_hedgehog__dense_activation_squared_relu__prompt_kernel_o_22
    buffer_load_dword v7, v88, s[32:35], 0 offen sc1
parallel_sum__linear_kernel_hedgehog__dense_activation_squared_relu__prompt_kernel_o_22:
    s_waitcnt lgkmcnt(6)
    v_mfma_f32_32x32x16_bf16 v[8:23], v[40:43], a[84:87], v[8:23]
    ds_read_b64_tr_b16 v[80:81], v75 offset:22528
    ds_read_b64_tr_b16 v[82:83], v75 offset:23040
    v_mfma_f32_32x32x16_bf16 v[24:39], v[44:47], a[84:87], v[24:39]
    ds_read_b64_tr_b16 v[84:85], v75 offset:30720
    ds_read_b64_tr_b16 v[86:87], v75 offset:31232
    s_add_u32 m0, s51, 49152
    s_nop 0
    buffer_load_dwordx4 v73, s[12:15], s49 offen offset:0 lds
    s_waitcnt lgkmcnt(4)
    v_mfma_f32_32x32x16_bf16 v[8:23], v[48:51], a[88:91], v[8:23]
    v_mfma_f32_32x32x16_bf16 v[24:39], v[52:55], a[88:91], v[24:39]
    s_add_u32 m0, s51, 57216
    s_nop 0
    buffer_load_dwordx4 v73, s[12:15], s49 offen offset:128 lds
    s_add_u32 s49, s49, 221184
    s_waitcnt lgkmcnt(0)
    s_waitcnt vmcnt(8)
    s_barrier
    v_add_u32 v76, 0x8000, v76
    v_add_u32 v77, 0x8000, v77
    v_add_u32 v78, 0x8000, v78
    v_add_u32 v79, 0x8000, v79
    ds_read_b128 a[96:99], v76
    v_add_u32 v75, 0x8000, v75
    ds_read_b64_tr_b16 v[40:41], v75 offset:16384
    ds_read_b64_tr_b16 v[42:43], v75 offset:16896
    ds_read_b64_tr_b16 v[44:45], v75 offset:24576
    ds_read_b64_tr_b16 v[46:47], v75 offset:25088
    v_mfma_f32_32x32x16_bf16 v[8:23], v[80:83], a[92:95], v[8:23]
    ds_read_b128 a[100:103], v77
    v_mfma_f32_32x32x16_bf16 v[24:39], v[84:87], a[92:95], v[24:39]
    ds_read_b64_tr_b16 v[48:49], v75 offset:18432
    ds_read_b64_tr_b16 v[50:51], v75 offset:18944
    ds_read_b64_tr_b16 v[52:53], v75 offset:26624
    ds_read_b64_tr_b16 v[54:55], v75 offset:27136
    s_add_u32 m0, s51, 65536
    s_nop 0
    buffer_load_dwordx4 v72, s[8:11], s47 offen lds
    s_waitcnt lgkmcnt(5)
    v_mfma_f32_32x32x16_bf16 v[8:23], v[40:43], a[96:99], v[8:23]
    ds_read_b128 a[104:107], v78
    ds_read_b128 a[108:111], v79
    ds_read_b64_tr_b16 v[80:81], v75 offset:20480
    ds_read_b64_tr_b16 v[82:83], v75 offset:20992
    v_mfma_f32_32x32x16_bf16 v[24:39], v[44:47], a[96:99], v[24:39]
    ds_read_b64_tr_b16 v[84:85], v75 offset:28672
    ds_read_b64_tr_b16 v[86:87], v75 offset:29184
    s_add_u32 m0, s51, 73728
    s_nop 0
    buffer_load_dwordx4 v72, s[8:11], s48 offen lds
    s_add_u32 s47, s47, 128
    s_add_u32 s48, s48, 128
    s_waitcnt lgkmcnt(6)
    v_mfma_f32_32x32x16_bf16 v[8:23], v[48:51], a[100:103], v[8:23]
    ds_read_b64_tr_b16 v[40:41], v75 offset:22528
    ds_read_b64_tr_b16 v[42:43], v75 offset:23040
    v_mfma_f32_32x32x16_bf16 v[24:39], v[52:55], a[100:103], v[24:39]
    ds_read_b64_tr_b16 v[44:45], v75 offset:30720
    ds_read_b64_tr_b16 v[46:47], v75 offset:31232
    s_add_u32 m0, s51, 81920
    s_nop 0
    buffer_load_dwordx4 v73, s[12:15], s49 offen offset:0 lds
    s_waitcnt lgkmcnt(4)
    v_mfma_f32_32x32x16_bf16 v[8:23], v[80:83], a[104:107], v[8:23]
    v_mfma_f32_32x32x16_bf16 v[24:39], v[84:87], a[104:107], v[24:39]
    s_add_u32 m0, s51, 89984
    s_nop 0
    buffer_load_dwordx4 v73, s[12:15], s49 offen offset:128 lds
    s_add_u32 s49, s49, 221184
    s_waitcnt lgkmcnt(0)
    s_cmp_lg_u32 s40, 0
    s_cbranch_scc1 parallel_sum__linear_kernel_hedgehog__dense_activation_squared_relu__prompt_kernel_o_23
    s_waitcnt vmcnt(6)
    s_mov_b32 s52, 0x40000
parallel_sum__linear_kernel_hedgehog__dense_activation_squared_relu__prompt_kernel_sp_24:
    v_cmp_ne_u32 vcc, s82, v7
    s_nop 4
    s_cbranch_vccz parallel_sum__linear_kernel_hedgehog__dense_activation_squared_relu__prompt_kernel_sd_25
    s_sub_u32 s52, s52, 1
    s_cmp_eq_u32 s52, 0
    s_cbranch_scc1 parallel_sum__linear_kernel_hedgehog__dense_activation_squared_relu__prompt_kernel_sd_25
    s_sleep 8
    buffer_load_dword v7, v88, s[32:35], 0 offen sc1
    s_waitcnt vmcnt(0)
    s_branch parallel_sum__linear_kernel_hedgehog__dense_activation_squared_relu__prompt_kernel_sp_24
parallel_sum__linear_kernel_hedgehog__dense_activation_squared_relu__prompt_kernel_sd_25:
parallel_sum__linear_kernel_hedgehog__dense_activation_squared_relu__prompt_kernel_o_23:
    s_waitcnt vmcnt(8)
    s_barrier
    v_add_u32 v76, 0x8000, v76
    v_add_u32 v77, 0x8000, v77
    v_add_u32 v78, 0x8000, v78
    v_add_u32 v79, 0x8000, v79
    ds_read_b128 a[112:115], v76
    v_add_u32 v75, 0x8000, v75
    ds_read_b64_tr_b16 v[48:49], v75 offset:16384
    ds_read_b64_tr_b16 v[50:51], v75 offset:16896
    ds_read_b64_tr_b16 v[52:53], v75 offset:24576
    ds_read_b64_tr_b16 v[54:55], v75 offset:25088
    v_mfma_f32_32x32x16_bf16 v[8:23], v[40:43], a[108:111], v[8:23]
    ds_read_b128 a[116:119], v77
    v_mfma_f32_32x32x16_bf16 v[24:39], v[44:47], a[108:111], v[24:39]
    ds_read_b64_tr_b16 v[80:81], v75 offset:18432
    ds_read_b64_tr_b16 v[82:83], v75 offset:18944
    ds_read_b64_tr_b16 v[84:85], v75 offset:26624
    ds_read_b64_tr_b16 v[86:87], v75 offset:27136
    s_add_u32 m0, s51, 98304
    s_nop 0
    buffer_load_dwordx4 v74, s[36:39], s50 offen sc1 lds
    s_add_u32 s50, s50, 8192
    s_lshl_b32 s54, s44, 14
    s_add_u32 s54, s54, s51
    s_add_u32 s54, s54, 3211264
    s_add_u32 m0, s51, 8192
    s_nop 0
    buffer_load_dwordx4 v74, s[36:39], s54 offen sc1 lds
    s_add_u32 s54, s54, 8192
    s_add_u32 m0, s51, 16384
    s_nop 0
    buffer_load_dwordx4 v74, s[36:39], s54 offen sc1 lds
    v_and_b32 v2, 31, v1
    s_lshl_b32 s54, s43, 7
    s_lshl_b32 s55, s41, 5
    s_add_u32 s54, s54, s55
    v_add_u32 v2, s54, v2
    v_lshlrev_b32 v2, 3, v2
    s_mov_b32 s54, 3145728
    buffer_load_dwordx2 v[94:95], v2, s[36:39], s54 offen sc1
    s_waitcnt lgkmcnt(5)
    v_mfma_f32_32x32x16_bf16 v[8:23], v[48:51], a[112:115], v[8:23]
    ds_read_b128 a[120:123], v78
    ds_read_b128 a[124:127], v79
    ds_read_b64_tr_b16 v[40:41], v75 offset:20480
    ds_read_b64_tr_b16 v[42:43], v75 offset:20992
    v_mfma_f32_32x32x16_bf16 v[24:39], v[52:55], a[112:115], v[24:39]
    ds_read_b64_tr_b16 v[44:45], v75 offset:28672
    ds_read_b64_tr_b16 v[46:47], v75 offset:29184
    s_add_u32 m0, s51, 106496
    s_nop 0
    buffer_load_dwordx4 v74, s[36:39], s50 offen sc1 lds
    s_add_u32 s50, s50, 8192
    s_waitcnt lgkmcnt(6)
    v_mfma_f32_32x32x16_bf16 v[8:23], v[80:83], a[116:119], v[8:23]
    ds_read_b64_tr_b16 v[48:49], v75 offset:22528
    ds_read_b64_tr_b16 v[50:51], v75 offset:23040
    v_mfma_f32_32x32x16_bf16 v[24:39], v[84:87], a[116:119], v[24:39]
    ds_read_b64_tr_b16 v[52:53], v75 offset:30720
    ds_read_b64_tr_b16 v[54:55], v75 offset:31232
    s_add_u32 m0, s51, 114688
    s_nop 0
    buffer_load_dwordx4 v74, s[36:39], s50 offen sc1 lds
    s_add_u32 s50, s50, 8192
    s_waitcnt lgkmcnt(4)
    v_mfma_f32_32x32x16_bf16 v[8:23], v[40:43], a[120:123], v[8:23]
    v_mfma_f32_32x32x16_bf16 v[24:39], v[44:47], a[120:123], v[24:39]
    s_add_u32 m0, s51, 122880
    s_nop 0
    buffer_load_dwordx4 v74, s[36:39], s50 offen sc1 lds
    s_add_u32 s50, s50, 8192
    s_waitcnt lgkmcnt(0)
    s_waitcnt vmcnt(11)
    s_barrier
    v_subrev_u32 v76, 0x18000, v76
    v_subrev_u32 v77, 0x18000, v77
    v_subrev_u32 v78, 0x18000, v78
    v_subrev_u32 v79, 0x18000, v79
    ds_read_b128 a[128:131], v76
    v_subrev_u32 v75, 0x18000, v75
    ds_read_b64_tr_b16 v[80:81], v75 offset:16384
    ds_read_b64_tr_b16 v[82:83], v75 offset:16896
    ds_read_b64_tr_b16 v[84:85], v75 offset:24576
    ds_read_b64_tr_b16 v[86:87], v75 offset:25088
    v_mfma_f32_32x32x16_bf16 v[8:23], v[48:51], a[124:127], v[8:23]
    ds_read_b128 a[132:135], v77
    v_mfma_f32_32x32x16_bf16 v[24:39], v[52:55], a[124:127], v[24:39]
    ds_read_b64_tr_b16 v[40:41], v75 offset:18432
    ds_read_b64_tr_b16 v[42:43], v75 offset:18944
    ds_read_b64_tr_b16 v[44:45], v75 offset:26624
    ds_read_b64_tr_b16 v[46:47], v75 offset:27136
    s_add_u32 m0, s51, 131072
    s_nop 0
    buffer_load_dwordx4 v74, s[36:39], s50 offen sc1 lds
    s_add_u32 s50, s50, 8192
    s_waitcnt lgkmcnt(5)
    v_mfma_f32_32x32x16_bf16 v[8:23], v[80:83], a[128:131], v[8:23]
    ds_read_b128 a[136:139], v78
    ds_read_b128 a[140:143], v79
    ds_read_b64_tr_b16 v[48:49], v75 offset:20480
    ds_read_b64_tr_b16 v[50:51], v75 offset:20992
    v_mfma_f32_32x32x16_bf16 v[24:39], v[84:87], a[128:131], v[24:39]
    ds_read_b64_tr_b16 v[52:53], v75 offset:28672
    ds_read_b64_tr_b16 v[54:55], v75 offset:29184
    s_add_u32 m0, s51, 139264
    s_nop 0
    buffer_load_dwordx4 v74, s[36:39], s50 offen sc1 lds
    s_add_u32 s50, s50, 8192
    s_waitcnt lgkmcnt(6)
    v_mfma_f32_32x32x16_bf16 v[8:23], v[40:43], a[132:135], v[8:23]
    ds_read_b64_tr_b16 v[80:81], v75 offset:22528
    ds_read_b64_tr_b16 v[82:83], v75 offset:23040
    v_mfma_f32_32x32x16_bf16 v[24:39], v[44:47], a[132:135], v[24:39]
    ds_read_b64_tr_b16 v[84:85], v75 offset:30720
    ds_read_b64_tr_b16 v[86:87], v75 offset:31232
    s_add_u32 m0, s51, 147456
    s_nop 0
    buffer_load_dwordx4 v74, s[36:39], s50 offen sc1 lds
    s_add_u32 s50, s50, 8192
    s_waitcnt lgkmcnt(4)
    v_mfma_f32_32x32x16_bf16 v[8:23], v[48:51], a[136:139], v[8:23]
    v_mfma_f32_32x32x16_bf16 v[24:39], v[52:55], a[136:139], v[24:39]
    s_add_u32 m0, s51, 155648
    s_nop 0
    buffer_load_dwordx4 v74, s[36:39], s50 offen sc1 lds
    s_add_u32 s50, s50, 8192
    s_waitcnt lgkmcnt(0)
    s_waitcnt vmcnt(7)
    s_waitcnt vmcnt(11)
    s_barrier
    v_add_u32 v76, 0x8000, v76
    v_add_u32 v77, 0x8000, v77
    v_add_u32 v78, 0x8000, v78
    v_add_u32 v79, 0x8000, v79
    ds_read_b128 a[144:147], v76
    v_add_u32 v75, 0x8000, v75
    ds_read_b64_tr_b16 v[40:41], v75 offset:16384
    ds_read_b64_tr_b16 v[42:43], v75 offset:16896
    ds_read_b64_tr_b16 v[44:45], v75 offset:24576
    ds_read_b64_tr_b16 v[46:47], v75 offset:25088
    v_mfma_f32_32x32x16_bf16 v[8:23], v[80:83], a[140:143], v[8:23]
    ds_read_b128 a[148:151], v77
    v_mfma_f32_32x32x16_bf16 v[24:39], v[84:87], a[140:143], v[24:39]
    ds_read_b64_tr_b16 v[48:49], v75 offset:18432
    ds_read_b64_tr_b16 v[50:51], v75 offset:18944
    ds_read_b64_tr_b16 v[52:53], v75 offset:26624
    ds_read_b64_tr_b16 v[54:55], v75 offset:27136
    s_add_u32 m0, s51, 32768
    s_nop 0
    buffer_load_dwordx4 v74, s[36:39], s50 offen sc1 lds
    s_add_u32 s50, s50, 8192
    s_waitcnt lgkmcnt(5)
    v_mfma_f32_32x32x16_bf16 v[8:23], v[40:43], a[144:147], v[8:23]
    ds_read_b128 a[152:155], v78
    ds_read_b128 a[156:159], v79
    ds_read_b64_tr_b16 v[80:81], v75 offset:20480
    ds_read_b64_tr_b16 v[82:83], v75 offset:20992
    v_mfma_f32_32x32x16_bf16 v[24:39], v[44:47], a[144:147], v[24:39]
    ds_read_b64_tr_b16 v[84:85], v75 offset:28672
    ds_read_b64_tr_b16 v[86:87], v75 offset:29184
    s_add_u32 m0, s51, 40960
    s_nop 0
    buffer_load_dwordx4 v74, s[36:39], s50 offen sc1 lds
    s_add_u32 s50, s50, 8192
    v_rsq_f32 v76, v95
    v_sqrt_f32 v88, v95
    v_cvt_pk_bf16_f32 v64, v94, v94
    v_and_b32 v67, 0xffff0000, v64
    v_sub_f32 v67, v94, v67
    v_cvt_pk_bf16_f32 v65, v67, v67
    v_and_b32 v66, 0xffff0000, v65
    v_sub_f32 v67, v67, v66
    v_cvt_pk_bf16_f32 v66, v67, v67
    v_cvt_pk_bf16_f32 v68, v88, v88
    v_and_b32 v71, 0xffff0000, v68
    v_sub_f32 v71, v88, v71
    v_cvt_pk_bf16_f32 v69, v71, v71
    v_and_b32 v70, 0xffff0000, v69
    v_sub_f32 v71, v71, v70
    v_cvt_pk_bf16_f32 v70, v71, v71
    v_bfi_b32 v92, s87, v64, v65
    v_bfi_b32 v93, s87, v64, v66
    v_bfi_b32 v94, s87, v65, v64
    v_bfi_b32 v95, s87, v68, v69
    v_and_b32 v70, s87, v70
    v_mov_b32 v71, 0
    v_cndmask_b32 v92, v92, v70, s[80:81]
    v_cndmask_b32 v93, v93, v71, s[80:81]
    v_cndmask_b32 v94, v94, v71, s[80:81]
    v_cndmask_b32 v95, v95, v71, s[80:81]
    v_mul_f32 v78, v76, v76
    v_mul_f32 v77, 0x3fb8aa3b, v76
    v_mov_b32 v79, v78
    v_and_b32 v2, 31, v1
    s_lshl_b32 s54, s42, 5
    v_add_u32 v2, s54, v2
    v_lshlrev_b32 v91, 2, v2
    v_lshlrev_b32 v90, 1, v2
    s_waitcnt lgkmcnt(6)
    v_mfma_f32_32x32x16_bf16 v[8:23], v[48:51], a[148:151], v[8:23]
    ds_read_b64_tr_b16 v[40:41], v75 offset:22528
    ds_read_b64_tr_b16 v[42:43], v75 offset:23040
    v_mfma_f32_32x32x16_bf16 v[24:39], v[52:55], a[148:151], v[24:39]
    ds_read_b64_tr_b16 v[44:45], v75 offset:30720
    ds_read_b64_tr_b16 v[46:47], v75 offset:31232
    s_add_u32 m0, s51, 49152
    s_nop 0
    buffer_load_dwordx4 v74, s[36:39], s50 offen sc1 lds
    s_add_u32 s50, s50, 8192
    v_add_u32 v5, 8192, v91
    ds_read2st64_b32 v[64:65], v5 offset0:0 offset1:4
    ds_read2st64_b32 v[66:67], v5 offset0:8 offset1:12
    ds_read2st64_b32 v[68:69], v5 offset0:16 offset1:20
    ds_read2st64_b32 v[70:71], v5 offset0:24 offset1:28
    ds_read_u16 v89, v90 offset:0
    s_waitcnt lgkmcnt(1)
    v_pk_add_f32 v[64:65], v[64:65], v[66:67]
    v_pk_add_f32 v[68:69], v[68:69], v[70:71]
    v_pk_add_f32 v[64:65], v[64:65], v[68:69]
    v_add_f32 v88, v64, v65
    ds_read2st64_b32 v[64:65], v5 offset0:32 offset1:36
    ds_read2st64_b32 v[66:67], v5 offset0:40 offset1:44
    ds_read2st64_b32 v[68:69], v5 offset0:48 offset1:52
    ds_read2st64_b32 v[70:71], v5 offset0:56 offset1:60
    s_waitcnt lgkmcnt(0)
    v_pk_add_f32 v[64:65], v[64:65], v[66:67]
    v_pk_add_f32 v[68:69], v[68:69], v[70:71]
    v_pk_add_f32 v[64:65], v[64:65], v[68:69]
    v_add_f32 v64, v64, v65
    v_add_f32 v88, v88, v64
    v_cvt_pk_bf16_f32 v64, v88, v88
    v_and_b32 v67, 0xffff0000, v64
    v_sub_f32 v67, v88, v67
    v_cvt_pk_bf16_f32 v65, v67, v67
    v_and_b32 v66, 0xffff0000, v65
    v_sub_f32 v67, v67, v66
    v_cvt_pk_bf16_f32 v66, v67, v67
    v_bfi_b32 v57, s87, v65, v64
    v_bfi_b32 v58, s87, v65, v66
    v_mov_b32 v67, 0
    s_waitcnt lgkmcnt(4)
    v_lshl_or_b32 v59, v89, 16, v89
    v_cndmask_b32 v56, v64, v89, s[80:81]
    v_cndmask_b32 v59, v59, v67, s[80:81]
    v_cndmask_b32 v57, v57, v67, s[80:81]
    v_cndmask_b32 v58, v58, v67, s[80:81]
    s_waitcnt lgkmcnt(13)
    v_mfma_f32_32x32x16_bf16 v[8:23], v[80:83], a[152:155], v[8:23]
    v_mfma_f32_32x32x16_bf16 v[24:39], v[84:87], a[152:155], v[24:39]
    s_add_u32 m0, s51, 57344
    s_nop 0
    buffer_load_dwordx4 v74, s[36:39], s50 offen sc1 lds
    s_add_u32 s50, s50, 8192
    v_add_u32 v5, 8448, v91
    ds_read2st64_b32 v[64:65], v5 offset0:0 offset1:4
    ds_read2st64_b32 v[66:67], v5 offset0:8 offset1:12
    ds_read2st64_b32 v[68:69], v5 offset0:16 offset1:20
    ds_read2st64_b32 v[70:71], v5 offset0:24 offset1:28
    ds_read_u16 v89, v90 offset:128
    s_waitcnt lgkmcnt(1)
    v_pk_add_f32 v[64:65], v[64:65], v[66:67]
    v_pk_add_f32 v[68:69], v[68:69], v[70:71]
    v_pk_add_f32 v[64:65], v[64:65], v[68:69]
    v_add_f32 v88, v64, v65
    ds_read2st64_b32 v[64:65], v5 offset0:32 offset1:36
    ds_read2st64_b32 v[66:67], v5 offset0:40 offset1:44
    ds_read2st64_b32 v[68:69], v5 offset0:48 offset1:52
    ds_read2st64_b32 v[70:71], v5 offset0:56 offset1:60
    s_waitcnt lgkmcnt(0)
    v_pk_add_f32 v[64:65], v[64:65], v[66:67]
    v_pk_add_f32 v[68:69], v[68:69], v[70:71]
    v_pk_add_f32 v[64:65], v[64:65], v[68:69]
    v_add_f32 v64, v64, v65
    v_add_f32 v88, v88, v64
    v_cvt_pk_bf16_f32 v64, v88, v88
    v_and_b32 v67, 0xffff0000, v64
    v_sub_f32 v67, v88, v67
    v_cvt_pk_bf16_f32 v65, v67, v67
    v_and_b32 v66, 0xffff0000, v65
    v_sub_f32 v67, v67, v66
    v_cvt_pk_bf16_f32 v66, v67, v67
    v_bfi_b32 v61, s87, v65, v64
    v_bfi_b32 v62, s87, v65, v66
    v_mov_b32 v67, 0
    s_waitcnt lgkmcnt(4)
    v_lshl_or_b32 v63, v89, 16, v89
    v_cndmask_b32 v60, v64, v89, s[80:81]
    v_cndmask_b32 v63, v63, v67, s[80:81]
    v_cndmask_b32 v61, v61, v67, s[80:81]
    v_cndmask_b32 v62, v62, v67, s[80:81]
    s_waitcnt lgkmcnt(15)
    s_waitcnt vmcnt(8)
    s_barrier
    v_mfma_f32_32x32x16_bf16 v[8:23], v[40:43], a[156:159], v[8:23]
    v_mfma_f32_32x32x16_bf16 v[24:39], v[44:47], a[156:159], v[24:39]
    s_add_u32 m0, s51, 65536
    s_nop 0
    buffer_load_dwordx4 v74, s[36:39], s50 offen sc1 lds
    s_add_u32 s50, s50, 8192
    s_add_u32 m0, s51, 73728
    s_nop 0
    buffer_load_dwordx4 v74, s[36:39], s50 offen sc1 lds
    s_add_u32 s50, s50, 8192
    s_add_u32 m0, s51, 81920
    s_nop 0
    buffer_load_dwordx4 v74, s[36:39], s50 offen sc1 lds
    s_add_u32 s50, s50, 8192
    s_add_u32 m0, s51, 90112
    s_nop 0
    buffer_load_dwordx4 v74, s[36:39], s50 offen sc1 lds
    s_add_u32 s50, s50, 8192
    v_mfma_f32_32x32x16_bf16 v[8:23], v[56:59], v[92:95], v[8:23]
    v_mfma_f32_32x32x16_bf16 v[24:39], v[60:63], v[92:95], v[24:39]
    s_lshl_b32 s54, s43, 1
    s_lshr_b32 s55, s41, 1
    s_add_u32 s54, s54, s55
    s_mul_i32 s54, s54, 74
    s_lshl_b32 s55, s46, 1
    s_add_u32 s54, s54, s55
    s_add_u32 s54, s54, s42
    s_lshl_b32 s54, s54, 12
    s_and_b32 s55, s41, 1
    s_lshl_b32 s55, s55, 11
    s_add_u32 s54, s54, s55
    v_bfe_u32 v2, v1, 4, 1
    v_lshlrev_b32 v90, 10, v2
    v_lshl_add_u32 v90, v6, 9, v90
    v_and_b32 v2, 15, v1
    v_lshl_add_u32 v90, v2, 4, v90
    v_max_f32 v8, 0, v8
    v_max_f32 v9, 0, v9
    v_max_f32 v10, 0, v10
    v_max_f32 v11, 0, v11
    v_max_f32 v12, 0, v12
    v_max_f32 v13, 0, v13
    v_max_f32 v14, 0, v14
    v_max_f32 v15, 0, v15
    v_max_f32 v16, 0, v16
    v_max_f32 v17, 0, v17
    v_max_f32 v18, 0, v18
    v_max_f32 v19, 0, v19
    v_max_f32 v20, 0, v20
    v_max_f32 v21, 0, v21
    v_max_f32 v22, 0, v22
    v_max_f32 v23, 0, v23
    v_pk_mul_f32 v[8:9], v[8:9], v[8:9]
    v_pk_mul_f32 v[10:11], v[10:11], v[10:11]
    v_pk_mul_f32 v[12:13], v[12:13], v[12:13]
    v_pk_mul_f32 v[14:15], v[14:15], v[14:15]
    v_pk_mul_f32 v[16:17], v[16:17], v[16:17]
    v_pk_mul_f32 v[18:19], v[18:19], v[18:19]
    v_pk_mul_f32 v[20:21], v[20:21], v[20:21]
    v_pk_mul_f32 v[22:23], v[22:23], v[22:23]
    v_pk_mul_f32 v[8:9], v[8:9], v[78:79]
    v_pk_mul_f32 v[10:11], v[10:11], v[78:79]
    v_pk_mul_f32 v[12:13], v[12:13], v[78:79]
    v_pk_mul_f32 v[14:15], v[14:15], v[78:79]
    v_pk_mul_f32 v[16:17], v[16:17], v[78:79]
    v_pk_mul_f32 v[18:19], v[18:19], v[78:79]
    v_pk_mul_f32 v[20:21], v[20:21], v[78:79]
    v_pk_mul_f32 v[22:23], v[22:23], v[78:79]
    v_cvt_pk_bf16_f32 v8, v8, v9
    v_cvt_pk_bf16_f32 v9, v10, v11
    v_cvt_pk_bf16_f32 v10, v12, v13
    v_cvt_pk_bf16_f32 v11, v14, v15
    v_cvt_pk_bf16_f32 v12, v16, v17
    v_cvt_pk_bf16_f32 v13, v18, v19
    v_cvt_pk_bf16_f32 v14, v20, v21
    v_cvt_pk_bf16_f32 v15, v22, v23
    buffer_store_dwordx4 v[8:11], v90, s[16:19], s54 offen offset:0 sc1
    buffer_store_dwordx4 v[12:15], v90, s[16:19], s54 offen offset:256 sc1
    v_max_f32 v24, 0, v24
    v_max_f32 v25, 0, v25
    v_max_f32 v26, 0, v26
    v_max_f32 v27, 0, v27
    v_max_f32 v28, 0, v28
    v_max_f32 v29, 0, v29
    v_max_f32 v30, 0, v30
    v_max_f32 v31, 0, v31
    v_max_f32 v32, 0, v32
    v_max_f32 v33, 0, v33
    v_max_f32 v34, 0, v34
    v_max_f32 v35, 0, v35
    v_max_f32 v36, 0, v36
    v_max_f32 v37, 0, v37
    v_max_f32 v38, 0, v38
    v_max_f32 v39, 0, v39
    v_pk_mul_f32 v[24:25], v[24:25], v[24:25]
    v_pk_mul_f32 v[26:27], v[26:27], v[26:27]
    v_pk_mul_f32 v[28:29], v[28:29], v[28:29]
    v_pk_mul_f32 v[30:31], v[30:31], v[30:31]
    v_pk_mul_f32 v[32:33], v[32:33], v[32:33]
    v_pk_mul_f32 v[34:35], v[34:35], v[34:35]
    v_pk_mul_f32 v[36:37], v[36:37], v[36:37]
    v_pk_mul_f32 v[38:39], v[38:39], v[38:39]
    v_pk_mul_f32 v[24:25], v[24:25], v[78:79]
    v_pk_mul_f32 v[26:27], v[26:27], v[78:79]
    v_pk_mul_f32 v[28:29], v[28:29], v[78:79]
    v_pk_mul_f32 v[30:31], v[30:31], v[78:79]
    v_pk_mul_f32 v[32:33], v[32:33], v[78:79]
    v_pk_mul_f32 v[34:35], v[34:35], v[78:79]
    v_pk_mul_f32 v[36:37], v[36:37], v[78:79]
    v_pk_mul_f32 v[38:39], v[38:39], v[78:79]
    v_cvt_pk_bf16_f32 v24, v24, v25
    v_cvt_pk_bf16_f32 v25, v26, v27
    v_cvt_pk_bf16_f32 v26, v28, v29
    v_cvt_pk_bf16_f32 v27, v30, v31
    v_cvt_pk_bf16_f32 v28, v32, v33
    v_cvt_pk_bf16_f32 v29, v34, v35
    v_cvt_pk_bf16_f32 v30, v36, v37
    v_cvt_pk_bf16_f32 v31, v38, v39
    s_add_u32 s54, s54, 8192
    buffer_store_dwordx4 v[24:27], v90, s[16:19], s54 offen offset:0 sc1
    buffer_store_dwordx4 v[28:31], v90, s[16:19], s54 offen offset:256 sc1
    s_branch parallel_sum__linear_kernel_hedgehog__dense_activation_squared_relu__prompt_kernel_joinA
parallel_sum__linear_kernel_hedgehog__dense_activation_squared_relu__prompt_kernel_nl1:
    s_or_b32 s54, s2, s40
    s_cmp_lg_u32 s54, 0
    s_cbranch_scc1 parallel_sum__linear_kernel_hedgehog__dense_activation_squared_relu__prompt_kernel_o_26
    s_memrealtime s[54:55]
    s_waitcnt lgkmcnt(0)
    s_or_b32 s54, s54, 1
    v_mov_b32 v3, s54
    v_mov_b32 v2, 0
    buffer_store_dword v3, v2, s[24:27], 0 offen sc1
parallel_sum__linear_kernel_hedgehog__dense_activation_squared_relu__prompt_kernel_o_26:
    s_add_u32 m0, s51, 65536
    s_nop 0
    buffer_load_dwordx4 v72, s[8:11], s47 offen lds
    s_add_u32 m0, s51, 73728
    s_nop 0
    buffer_load_dwordx4 v72, s[8:11], s48 offen lds
    s_add_u32 s47, s47, 128
    s_add_u32 s48, s48, 128
    s_add_u32 m0, s51, 81920
    s_nop 0
    buffer_load_dwordx4 v73, s[12:15], s49 offen offset:0 lds
    s_add_u32 s49, s49, 221184
    s_cmp_lg_u32 s40, 0
    s_cbranch_scc1 parallel_sum__linear_kernel_hedgehog__dense_activation_squared_relu__prompt_kernel_o_27
    v_mov_b32 v94, 0
    buffer_load_dword v95, v94, s[24:27], 0 offen sc1
parallel_sum__linear_kernel_hedgehog__dense_activation_squared_relu__prompt_kernel_o_27:
    s_add_u32 m0, s51, 98304
    s_nop 0
    buffer_load_dwordx4 v72, s[8:11], s47 offen lds
    s_add_u32 m0, s51, 106496
    s_nop 0
    buffer_load_dwordx4 v72, s[8:11], s48 offen lds
    s_add_u32 s47, s47, 128
    s_add_u32 s48, s48, 128
    s_add_u32 m0, s51, 114688
    s_nop 0
    buffer_load_dwordx4 v73, s[12:15], s49 offen offset:0 lds
    s_add_u32 s49, s49, 221184
    s_cmp_lg_u32 s40, 2
    s_cbranch_scc1 parallel_sum__linear_kernel_hedgehog__dense_activation_squared_relu__prompt_kernel_o_28
    s_mov_b32 s28, s58
    s_mov_b32 s29, s59
    s_mov_b32 s30, 3456
    s_lshl_b32 s54, s46, 7
    v_lshlrev_b32 v2, 2, v1
    s_mov_b32 m0, 0
    s_nop 0
    buffer_load_dword v2, s[28:31], s54 offen lds
parallel_sum__linear_kernel_hedgehog__dense_activation_squared_relu__prompt_kernel_o_28:
    s_cmp_ge_u32 s40, 2
    s_cbranch_scc1 parallel_sum__linear_kernel_hedgehog__dense_activation_squared_relu__prompt_kernel_o_29
    s_mov_b32 s28, s60
    s_mov_b32 s29, s61
    s_mov_b32 s30, 25600
    s_mul_i32 s54, s44, 1600
    s_add_u32 s54, s54, s51
    s_add_u32 m0, s51, 5120
    s_nop 0
    buffer_load_dwordx4 v74, s[28:31], s54 offen lds
parallel_sum__linear_kernel_hedgehog__dense_activation_squared_relu__prompt_kernel_o_29:
    v_and_b32 v2, 31, v1
    v_lshrrev_b32 v4, 1, v2
    v_and_b32 v4, 7, v4
    v_xor_b32 v4, v4, v6
    v_lshlrev_b32 v4, 4, v4
    s_lshl_b32 s54, s41, 12
    v_lshlrev_b32 v5, 7, v2
    v_add_u32 v5, s54, v5
    v_add_u32 v76, v5, v4
    v_xor_b32 v77, 32, v76
    v_xor_b32 v78, 64, v76
    v_xor_b32 v79, 96, v76
    v_bfe_u32 v11, v1, 2, 2
    v_bfe_u32 v2, v1, 4, 1
    v_and_b32 v3, 3, v1
    v_lshl_add_u32 v12, v2, 2, v3
    v_cmp_eq_u32 s[74:75], 1, v3
    v_cmp_eq_u32 s[76:77], 2, v3
    v_cmp_eq_u32 s[78:79], 3, v3
    v_cmp_lt_u32 s[80:81], 31, v1
    s_mov_b32 s87, 0xffff
    v_lshl_add_u32 v2, v6, 3, v11
    v_lshlrev_b32 v75, 7, v2
    v_lshrrev_b32 v3, 1, v12
    s_lshl_b32 s54, s42, 2
    v_add_u32 v3, s54, v3
    v_bfe_u32 v4, v11, 1, 1
    v_lshlrev_b32 v4, 2, v4
    v_xor_b32 v3, v3, v4
    v_lshl_add_u32 v75, v3, 4, v75
    v_and_b32 v3, 1, v12
    v_lshl_add_u32 v75, v3, 3, v75
    s_lshl_b32 s54, s41, 12
    v_add_u32 v13, s54, v75
    v_sub_u32 v2, 4, v11
    v_and_b32 v2, 3, v2
    v_lshlrev_b32 v2, 2, v2
    v_lshl_add_u32 v2, v6, 1, v2
    v_mul_u32_u24 v2, 240, v2
    s_mul_i32 s54, s42, 40
    s_mul_i32 s55, s41, 3840
    s_add_u32 s54, s54, s55
    v_add_u32 v2, s54, v2
    v_lshrrev_b32 v3, 1, v12
    v_and_b32 v4, 1, v12
    v_mul_u32_u24 v5, 160, v4
    v_lshl_add_u32 v5, v3, 3, v5
    v_add_u32 v9, v2, v5
    s_mov_b32 s54, 131072
    v_add_u32 v9, s54, v9
    v_add_u32 v2, s54, v2
    s_mov_b32 s54, 143360
    v_add_u32 v13, s54, v13
    v_mov_b32 v3, 0x6850c020
    v_mov_b32 v4, 0x50607058
    v_cmp_gt_u32 vcc, 4, v12
    s_nop 1
    v_cndmask_b32 v3, v4, v3, vcc
    v_and_b32 v4, 3, v12
    v_lshlrev_b32 v4, 3, v4
    v_lshrrev_b32 v3, v4, v3
    v_and_b32 v3, 0xff, v3
    v_add_u32 v10, v2, v3
    v_mov_b32 v92, 0x3f803f80
    v_mov_b32 v93, 0x3f803f80
    v_mov_b32 v80, 0
    v_mov_b32 v81, 0
    v_mov_b32 v82, 0
    v_mov_b32 v83, 0
    ds_write_b128 v74, v[80:83] offset:512
    ds_write_b128 v74, v[80:83] offset:1536
    ds_write_b128 v74, v[80:83] offset:2560
    ds_write_b128 v74, v[80:83] offset:7168
    v_lshlrev_b32 v2, 2, v1
    v_mov_b32 v3, 0
    ds_write_b32 v2, v3 offset:256
    s_waitcnt vmcnt(6)
    s_waitcnt lgkmcnt(0)
    s_barrier
    s_lshl_b32 s54, s41, 4
    s_add_u32 s54, s54, s43
    s_cmp_ge_u32 s54, 40
    s_cbranch_scc1 parallel_sum__linear_kernel_hedgehog__dense_activation_squared_relu__prompt_kernel_o_30
    ds_read_b64_tr_b16 v[40:41], v9 offset:0
    ds_read_b64_tr_b16 v[42:43], v9 offset:240
    ds_read_b64_tr_b16 v[44:45], v10 offset:0
    ds_read_b64_tr_b16 v[46:47], v10 offset:240
    ds_read_b64_tr_b16 v[48:49], v13 offset:0
    ds_read_b64_tr_b16 v[50:51], v13 offset:512
    s_mul_i32 s55, s44, 40
    s_add_u32 s54, s54, s55
    s_lshl_b32 s54, s54, 12
    s_lshl_b32 s55, s42, 11
    s_add_u32 s54, s54, s55
    s_waitcnt lgkmcnt(2)
    buffer_store_dwordx4 v[40:43], v74, s[36:39], s54 offen offset:0 sc1
    buffer_store_dwordx4 v[44:47], v74, s[36:39], s54 offen offset:1024 sc1
    s_waitcnt lgkmcnt(0)
    v_mfma_f32_4x4x4_16b_bf16 v[56:59], v[40:41], v[92:93], 0
    v_mfma_f32_4x4x4_16b_bf16 v[60:63], v[44:45], v[92:93], 0
    v_mfma_f32_4x4x4_16b_bf16 v[64:67], v[48:49], v[92:93], 0
    v_mfma_f32_4x4x4_16b_bf16 v[56:59], v[42:43], v[92:93], v[56:59]
    v_mfma_f32_4x4x4_16b_bf16 v[60:63], v[46:47], v[92:93], v[60:63]
    v_mfma_f32_4x4x4_16b_bf16 v[64:67], v[50:51], v[92:93], v[64:67]
    v_and_b32 v2, 31, v1
    v_lshlrev_b32 v2, 2, v2
    s_lshl_b32 s55, s41, 10
    s_lshl_b32 s54, s42, 7
    s_add_u32 s54, s54, s55
    v_add_u32 v3, s54, v2
    s_lshl_b32 s54, s42, 8
    s_add_u32 s54, s54, s55
    v_add_u32 v2, s54, v2
    v_cndmask_b32 v88, v56, v57, s[74:75]
    v_cndmask_b32 v88, v88, v58, s[76:77]
    v_cndmask_b32 v88, v88, v59, s[78:79]
    v_cndmask_b32 v89, v60, v61, s[74:75]
    v_cndmask_b32 v89, v89, v62, s[76:77]
    v_cndmask_b32 v89, v89, v63, s[78:79]
    v_cndmask_b32 v90, v64, v65, s[74:75]
    v_cndmask_b32 v90, v90, v66, s[76:77]
    v_cndmask_b32 v90, v90, v67, s[78:79]
    v_mov_b32 v4, v88
    s_nop 1
    v_permlane32_swap_b32 v88, v4
    v_add_f32 v88, v88, v4
    v_mov_b32 v4, v89
    s_nop 1
    v_permlane32_swap_b32 v89, v4
    v_add_f32 v89, v89, v4
    v_mov_b32 v4, v90
    s_nop 1
    v_permlane32_swap_b32 v90, v4
    v_add_f32 v90, v90, v4
    ds_write_b32 v2, v88 offset:1024
    ds_write_b32 v2, v89 offset:1152
    ds_write_b32 v3, v90 offset:512
parallel_sum__linear_kernel_hedgehog__dense_activation_squared_relu__prompt_kernel_o_30:
    s_waitcnt lgkmcnt(0)
    s_barrier
    s_cmp_lg_u32 s40, 4
    s_cbranch_scc1 parallel_sum__linear_kernel_hedgehog__dense_activation_squared_relu__prompt_kernel_o_31
    s_nop 0
    ds_read_b128 v[56:59], v74 offset:512
    ds_read_b128 v[60:63], v74 offset:1536
    ds_read_b128 v[64:67], v74 offset:2560
    s_lshl_b32 s54, s44, 4
    s_add_u32 s54, s54, s43
    s_lshl_b32 s54, s54, 10
    s_add_u32 s54, s54, 3211264
    s_waitcnt lgkmcnt(0)
    v_add_f32 v56, v56, v60
    v_add_f32 v56, v56, v64
    v_add_f32 v57, v57, v61
    v_add_f32 v57, v57, v65
    v_add_f32 v58, v58, v62
    v_add_f32 v58, v58, v66
    v_add_f32 v59, v59, v63
    v_add_f32 v59, v59, v67
    buffer_store_dwordx4 v[56:59], v74, s[36:39], s54 offen sc1
parallel_sum__linear_kernel_hedgehog__dense_activation_squared_relu__prompt_kernel_o_31:
    s_add_u32 m0, s51, 131072
    s_nop 0
    buffer_load_dwordx4 v72, s[8:11], s47 offen lds
    s_add_u32 m0, s51, 139264
    s_nop 0
    buffer_load_dwordx4 v72, s[8:11], s48 offen lds
    s_add_u32 s47, s47, 128
    s_add_u32 s48, s48, 128
    s_add_u32 m0, s51, 147456
    s_nop 0
    buffer_load_dwordx4 v73, s[12:15], s49 offen offset:0 lds
    s_add_u32 s49, s49, 221184
    s_mul_i32 s83, s43, 5
    s_add_u32 s83, s83, s44
    s_add_u32 s83, s83, 1048565
    s_sub_u32 s83, s83, 1048576
    s_lshr_b32 s52, s83, 2
    s_and_b32 s53, s83, 3
    s_lshl_b32 s54, s52, 5
    s_and_b32 s55, s53, 1
    s_lshl_b32 s55, s55, 4
    s_add_u32 s54, s54, s55
    s_lshr_b32 s55, s53, 1
    s_lshl_b32 s55, s55, 2
    s_add_u32 s54, s54, s55
    s_add_u32 s55, s54, 8
    s_mov_b32 s28, s62
    s_mov_b32 s29, s63
    s_mov_b32 s30, 2211840
    s_mov_b32 s31, 0x20000
    s_cmp_lt_u32 s83, 216
    s_cbranch_scc1 parallel_sum__linear_kernel_hedgehog__dense_activation_squared_relu__prompt_kernel_po_32
    s_sub_u32 s52, s83, 216
    s_mul_i32 s53, s52, 205
    s_lshr_b32 s53, s53, 10
    s_mul_i32 s54, s53, 5
    s_sub_u32 s52, s52, s54
    s_mul_i32 s53, s53, 40
    s_lshl_b32 s52, s52, 3
    s_mov_b32 s54, 0x18140400
    s_mov_b32 s55, 0x10
    s_lshr_b64 s[54:55], s[54:55], s52
    s_and_b32 s54, s54, 0xff
    s_add_u32 s54, s54, s53
    s_add_u32 s55, s54, 8
    s_add_u32 s53, s53, 36
    s_cmp_eq_u32 s52, 32
    s_cselect_b32 s55, s53, s55
    s_mov_b32 s28, s64
    s_mov_b32 s29, s65
    s_mov_b32 s30, 819200
parallel_sum__linear_kernel_hedgehog__dense_activation_squared_relu__prompt_kernel_po_32:
    v_lshrrev_b32 v2, 3, v1
    s_sub_u32 s55, s55, 4
    v_add_u32 v3, s54, v2
    v_add_u32 v4, s55, v2
    v_cmp_gt_u32 vcc, 4, v2
    s_nop 1
    v_cndmask_b32 v3, v4, v3, vcc
    v_mul_u32_u24 v3, 1280, v3
    v_and_b32 v4, 7, v1
    v_lshl_add_u32 v3, v4, 4, v3
    s_lshl_b32 s52, s40, 7
    s_add_u32 m0, s51, 8192
    s_nop 0
    buffer_load_dwordx4 v3, s[28:31], s52 offen lds
    s_cmp_ge_u32 s40, 2
    s_cbranch_scc1 parallel_sum__linear_kernel_hedgehog__dense_activation_squared_relu__prompt_kernel_o_33
    s_add_u32 s52, s52, 1024
    s_add_u32 m0, s51, 16384
    s_nop 0
    buffer_load_dwordx4 v3, s[28:31], s52 offen lds
parallel_sum__linear_kernel_hedgehog__dense_activation_squared_relu__prompt_kernel_o_33:
    s_mul_i32 s84, s43, 5
    s_add_u32 s84, s84, s44
    s_add_u32 s84, s84, 1048645
    s_sub_u32 s84, s84, 1048576
    s_lshr_b32 s52, s84, 2
    s_and_b32 s53, s84, 3
    s_lshl_b32 s54, s52, 5
    s_and_b32 s55, s53, 1
    s_lshl_b32 s55, s55, 4
    s_add_u32 s54, s54, s55
    s_lshr_b32 s55, s53, 1
    s_lshl_b32 s55, s55, 2
    s_add_u32 s54, s54, s55
    s_add_u32 s55, s54, 8
    s_mov_b32 s28, s62
    s_mov_b32 s29, s63
    s_mov_b32 s30, 2211840
    s_mov_b32 s31, 0x20000
    s_cmp_lt_u32 s84, 216
    s_cbranch_scc1 parallel_sum__linear_kernel_hedgehog__dense_activation_squared_relu__prompt_kernel_po_34
    s_sub_u32 s52, s84, 216
    s_mul_i32 s53, s52, 205
    s_lshr_b32 s53, s53, 10
    s_mul_i32 s54, s53, 5
    s_sub_u32 s52, s52, s54
    s_mul_i32 s53, s53, 40
    s_lshl_b32 s52, s52, 3
    s_mov_b32 s54, 0x18140400
    s_mov_b32 s55, 0x10
    s_lshr_b64 s[54:55], s[54:55], s52
    s_and_b32 s54, s54, 0xff
    s_add_u32 s54, s54, s53
    s_add_u32 s55, s54, 8
    s_add_u32 s53, s53, 36
    s_cmp_eq_u32 s52, 32
    s_cselect_b32 s55, s53, s55
    s_mov_b32 s28, s64
    s_mov_b32 s29, s65
    s_mov_b32 s30, 819200
parallel_sum__linear_kernel_hedgehog__dense_activation_squared_relu__prompt_kernel_po_34:
    v_lshrrev_b32 v2, 3, v1
    s_sub_u32 s55, s55, 4
    v_add_u32 v3, s54, v2
    v_add_u32 v4, s55, v2
    v_cmp_gt_u32 vcc, 4, v2
    s_nop 1
    v_cndmask_b32 v3, v4, v3, vcc
    v_mul_u32_u24 v3, 1280, v3
    v_and_b32 v4, 7, v1
    v_lshl_add_u32 v3, v4, 4, v3
    s_lshl_b32 s52, s40, 7
    s_add_u32 m0, s51, 18432
    s_nop 0
    buffer_load_dwordx4 v3, s[28:31], s52 offen lds
    s_cmp_ge_u32 s40, 2
    s_cbranch_scc1 parallel_sum__linear_kernel_hedgehog__dense_activation_squared_relu__prompt_kernel_o_35
    s_add_u32 s52, s52, 1024
    s_add_u32 m0, s51, 26624
    s_nop 0
    buffer_load_dwordx4 v3, s[28:31], s52 offen lds
parallel_sum__linear_kernel_hedgehog__dense_activation_squared_relu__prompt_kernel_o_35:
    s_waitcnt vmcnt(12)
    s_barrier
    v_add_u32 v76, 0x8000, v76
    v_add_u32 v77, 0x8000, v77
    v_add_u32 v78, 0x8000, v78
    v_add_u32 v79, 0x8000, v79
    ds_read_b128 a[0:3], v76
    ds_read_b128 a[4:7], v77
    ds_read_b128 a[8:11], v78
    ds_read_b128 a[12:15], v79
    v_add_u32 v75, 0x8000, v75
    ds_read_b64_tr_b16 v[40:41], v75 offset:16384
    ds_read_b64_tr_b16 v[42:43], v75 offset:16896
    ds_read_b64_tr_b16 v[48:49], v75 offset:18432
    ds_read_b64_tr_b16 v[50:51], v75 offset:18944
    s_waitcnt lgkmcnt(2)
    v_mfma_f32_32x32x16_bf16 v[8:23], v[40:43], a[0:3], 0
    ds_read_b64_tr_b16 v[80:81], v75 offset:20480
    ds_read_b64_tr_b16 v[82:83], v75 offset:20992
    s_waitcnt lgkmcnt(2)
    v_mfma_f32_32x32x16_bf16 v[8:23], v[48:51], a[4:7], v[8:23]
    ds_read_b64_tr_b16 v[40:41], v75 offset:22528
    ds_read_b64_tr_b16 v[42:43], v75 offset:23040
    s_cmp_lg_u32 s40, 3
    s_cbranch_scc1 parallel_sum__linear_kernel_hedgehog__dense_activation_squared_relu__prompt_kernel_o_36
    s_waitcnt vmcnt(11)
    v_mfma_f32_4x4x4_16b_bf16 v[64:67], a[120:121], a[120:121], 0
    v_mfma_f32_4x4x4_16b_bf16 v[56:59], a[120:121], v[92:93], 0
    v_mfma_f32_4x4x4_16b_bf16 v[68:71], a[122:123], a[122:123], 0
    v_mfma_f32_4x4x4_16b_bf16 v[60:63], a[122:123], v[92:93], 0
    v_mfma_f32_4x4x4_16b_bf16 v[64:67], a[124:125], a[124:125], v[64:67]
    v_mfma_f32_4x4x4_16b_bf16 v[56:59], a[124:125], v[92:93], v[56:59]
    v_mfma_f32_4x4x4_16b_bf16 v[68:71], a[126:127], a[126:127], v[68:71]
    v_mfma_f32_4x4x4_16b_bf16 v[60:63], a[126:127], v[92:93], v[60:63]
    v_mfma_f32_4x4x4_16b_bf16 v[64:67], a[128:129], a[128:129], v[64:67]
    v_mfma_f32_4x4x4_16b_bf16 v[56:59], a[128:129], v[92:93], v[56:59]
    v_mfma_f32_4x4x4_16b_bf16 v[68:71], a[130:131], a[130:131], v[68:71]
    v_mfma_f32_4x4x4_16b_bf16 v[60:63], a[130:131], v[92:93], v[60:63]
    v_mfma_f32_4x4x4_16b_bf16 v[64:67], a[132:133], a[132:133], v[64:67]
    v_mfma_f32_4x4x4_16b_bf16 v[56:59], a[132:133], v[92:93], v[56:59]
    v_mfma_f32_4x4x4_16b_bf16 v[68:71], a[134:135], a[134:135], v[68:71]
    v_mfma_f32_4x4x4_16b_bf16 v[60:63], a[134:135], v[92:93], v[60:63]
    v_mfma_f32_4x4x4_16b_bf16 v[64:67], a[136:137], a[136:137], v[64:67]
    v_mfma_f32_4x4x4_16b_bf16 v[56:59], a[136:137], v[92:93], v[56:59]
    v_mfma_f32_4x4x4_16b_bf16 v[68:71], a[138:139], a[138:139], v[68:71]
    v_mfma_f32_4x4x4_16b_bf16 v[60:63], a[138:139], v[92:93], v[60:63]
    v_mfma_f32_4x4x4_16b_bf16 v[64:67], a[140:141], a[140:141], v[64:67]
    v_mfma_f32_4x4x4_16b_bf16 v[56:59], a[140:141], v[92:93], v[56:59]
    v_mfma_f32_4x4x4_16b_bf16 v[68:71], a[142:143], a[142:143], v[68:71]
    v_mfma_f32_4x4x4_16b_bf16 v[60:63], a[142:143], v[92:93], v[60:63]
    v_mfma_f32_4x4x4_16b_bf16 v[64:67], a[144:145], a[144:145], v[64:67]
    v_mfma_f32_4x4x4_16b_bf16 v[56:59], a[144:145], v[92:93], v[56:59]
    v_mfma_f32_4x4x4_16b_bf16 v[68:71], a[146:147], a[146:147], v[68:71]
    v_mfma_f32_4x4x4_16b_bf16 v[60:63], a[146:147], v[92:93], v[60:63]
    v_mfma_f32_4x4x4_16b_bf16 v[64:67], a[148:149], a[148:149], v[64:67]
    v_mfma_f32_4x4x4_16b_bf16 v[56:59], a[148:149], v[92:93], v[56:59]
    v_mfma_f32_4x4x4_16b_bf16 v[68:71], a[150:151], a[150:151], v[68:71]
    v_mfma_f32_4x4x4_16b_bf16 v[60:63], a[150:151], v[92:93], v[60:63]
    v_mfma_f32_4x4x4_16b_bf16 v[64:67], a[152:153], a[152:153], v[64:67]
    v_mfma_f32_4x4x4_16b_bf16 v[56:59], a[152:153], v[92:93], v[56:59]
    v_mfma_f32_4x4x4_16b_bf16 v[68:71], a[154:155], a[154:155], v[68:71]
    v_mfma_f32_4x4x4_16b_bf16 v[60:63], a[154:155], v[92:93], v[60:63]
    v_mfma_f32_4x4x4_16b_bf16 v[64:67], a[156:157], a[156:157], v[64:67]
    v_mfma_f32_4x4x4_16b_bf16 v[56:59], a[156:157], v[92:93], v[56:59]
    v_mfma_f32_4x4x4_16b_bf16 v[68:71], a[158:159], a[158:159], v[68:71]
    v_mfma_f32_4x4x4_16b_bf16 v[60:63], a[158:159], v[92:93], v[60:63]
    s_nop 2
    v_cndmask_b32 v2, v56, v57, s[74:75]
    v_cndmask_b32 v2, v2, v58, s[76:77]
    v_cndmask_b32 v2, v2, v59, s[78:79]
    v_cndmask_b32 v3, v60, v61, s[74:75]
    v_cndmask_b32 v3, v3, v62, s[76:77]
    v_cndmask_b32 v3, v3, v63, s[78:79]
    v_cndmask_b32 v4, v64, v65, s[74:75]
    v_cndmask_b32 v4, v4, v66, s[76:77]
    v_cndmask_b32 v4, v4, v67, s[78:79]
    v_cndmask_b32 v5, v68, v69, s[74:75]
    v_cndmask_b32 v5, v5, v70, s[76:77]
    v_cndmask_b32 v5, v5, v71, s[78:79]
    v_add_f32 v2, v2, v3
    v_add_f32 v4, v4, v5
    s_nop 0
    v_add_f32_dpp v2, v2, v2 quad_perm:[1,0,3,2] row_mask:0xf bank_mask:0xf
    v_add_f32_dpp v4, v4, v4 quad_perm:[1,0,3,2] row_mask:0xf bank_mask:0xf
    s_nop 0
    v_add_f32_dpp v2, v2, v2 quad_perm:[2,3,0,1] row_mask:0xf bank_mask:0xf
    v_add_f32_dpp v4, v4, v4 quad_perm:[2,3,0,1] row_mask:0xf bank_mask:0xf
    s_nop 0
    v_add_f32_dpp v2, v2, v2 row_half_mirror row_mask:0xf bank_mask:0xf
    v_add_f32_dpp v4, v4, v4 row_half_mirror row_mask:0xf bank_mask:0xf
    v_mul_f32 v2, 0xbacccccd, v2
    v_mul_f32 v3, 0x3acccccd, v4
    v_fma_f32 v3, -v2, v2, v3
    v_max_f32 v3, 0, v3
    v_add_f32 v3, 0x3727c5ac, v3
    v_lshrrev_b32 v4, 3, v1
    s_lshl_b32 s54, s43, 7
    s_lshl_b32 s55, s44, 3
    s_add_u32 s54, s54, s55
    v_add_u32 v4, s54, v4
    v_lshlrev_b32 v4, 3, v4
    s_mov_b32 s54, 3145728
    buffer_store_dwordx2 v[2:3], v4, s[36:39], s54 offen sc1
parallel_sum__linear_kernel_hedgehog__dense_activation_squared_relu__prompt_kernel_o_36:
    s_waitcnt lgkmcnt(2)
    v_mfma_f32_32x32x16_bf16 v[8:23], v[80:83], a[8:11], v[8:23]
    s_waitcnt lgkmcnt(0)
    s_waitcnt vmcnt(8)
    s_barrier
    v_add_u32 v76, 0x8000, v76
    v_add_u32 v77, 0x8000, v77
    v_add_u32 v78, 0x8000, v78
    v_add_u32 v79, 0x8000, v79
    ds_read_b128 a[16:19], v76
    v_add_u32 v75, 0x8000, v75
    ds_read_b64_tr_b16 v[48:49], v75 offset:16384
    ds_read_b64_tr_b16 v[50:51], v75 offset:16896
    v_mfma_f32_32x32x16_bf16 v[8:23], v[40:43], a[12:15], v[8:23]
    ds_read_b128 a[20:23], v77
    ds_read_b64_tr_b16 v[80:81], v75 offset:18432
    ds_read_b64_tr_b16 v[82:83], v75 offset:18944
    s_add_u32 m0, s51, 32768
    s_nop 0
    buffer_load_dwordx4 v72, s[8:11], s47 offen lds
    s_waitcnt lgkmcnt(3)
    v_mfma_f32_32x32x16_bf16 v[8:23], v[48:51], a[16:19], v[8:23]
    ds_read_b128 a[24:27], v78
    ds_read_b128 a[28:31], v79
    ds_read_b64_tr_b16 v[40:41], v75 offset:20480
    ds_read_b64_tr_b16 v[42:43], v75 offset:20992
    s_add_u32 m0, s51, 40960
    s_nop 0
    buffer_load_dwordx4 v72, s[8:11], s48 offen lds
    s_add_u32 s47, s47, 128
    s_add_u32 s48, s48, 128
    s_waitcnt lgkmcnt(4)
    v_mfma_f32_32x32x16_bf16 v[8:23], v[80:83], a[20:23], v[8:23]
    ds_read_b64_tr_b16 v[48:49], v75 offset:22528
    ds_read_b64_tr_b16 v[50:51], v75 offset:23040
    s_add_u32 m0, s51, 49152
    s_nop 0
    buffer_load_dwordx4 v73, s[12:15], s49 offen offset:0 lds
    s_add_u32 s49, s49, 221184
    s_waitcnt lgkmcnt(2)
    v_mfma_f32_32x32x16_bf16 v[8:23], v[40:43], a[24:27], v[8:23]
    s_waitcnt lgkmcnt(0)
    s_waitcnt vmcnt(7)
    s_cmp_lg_u32 s40, 0
    s_cbranch_scc1 parallel_sum__linear_kernel_hedgehog__dense_activation_squared_relu__prompt_kernel_o_37
    s_waitcnt vmcnt(8)
    s_mov_b32 s52, 0x40000
parallel_sum__linear_kernel_hedgehog__dense_activation_squared_relu__prompt_kernel_sp_38:
    v_cmp_eq_u32 vcc, 0, v95
    s_nop 4
    s_cbranch_vccz parallel_sum__linear_kernel_hedgehog__dense_activation_squared_relu__prompt_kernel_sd_39
    s_sub_u32 s52, s52, 1
    s_cmp_eq_u32 s52, 0
    s_cbranch_scc1 parallel_sum__linear_kernel_hedgehog__dense_activation_squared_relu__prompt_kernel_sd_39
    s_sleep 8
    buffer_load_dword v95, v94, s[24:27], 0 offen sc1
    s_waitcnt vmcnt(0)
    s_branch parallel_sum__linear_kernel_hedgehog__dense_activation_squared_relu__prompt_kernel_sp_38
parallel_sum__linear_kernel_hedgehog__dense_activation_squared_relu__prompt_kernel_sd_39:
    v_mov_b32 v2, 256
    v_readfirstlane_b32 s82, v95
    ds_write_b32 v2, v95
    s_waitcnt lgkmcnt(0)
parallel_sum__linear_kernel_hedgehog__dense_activation_squared_relu__prompt_kernel_o_37:
    s_waitcnt vmcnt(8)
    s_barrier
    v_add_u32 v76, 0x8000, v76
    v_add_u32 v77, 0x8000, v77
    v_add_u32 v78, 0x8000, v78
    v_add_u32 v79, 0x8000, v79
    ds_read_b128 a[32:35], v76
    v_add_u32 v75, 0x8000, v75
    ds_read_b64_tr_b16 v[80:81], v75 offset:16384
    ds_read_b64_tr_b16 v[82:83], v75 offset:16896
    v_mfma_f32_32x32x16_bf16 v[8:23], v[48:51], a[28:31], v[8:23]
    ds_read_b128 a[36:39], v77
    ds_read_b64_tr_b16 v[40:41], v75 offset:18432
    ds_read_b64_tr_b16 v[42:43], v75 offset:18944
    s_add_u32 m0, s51, 65536
    s_nop 0
    buffer_load_dwordx4 v72, s[8:11], s47 offen lds
    s_cmp_lg_u32 s40, 0
    s_cbranch_scc1 parallel_sum__linear_kernel_hedgehog__dense_activation_squared_relu__prompt_kernel_o_40
    s_lshl_b32 s54, s44, 7
    s_lshl_b32 s55, s43, 2
    s_add_u32 s54, s54, s55
    s_add_u32 s54, s54, 0
    v_mov_b32 v2, s54
    v_mov_b32 v3, s82
    buffer_store_dword v3, v2, s[32:35], 0 offen sc1
parallel_sum__linear_kernel_hedgehog__dense_activation_squared_relu__prompt_kernel_o_40:
    s_waitcnt lgkmcnt(3)
    v_mfma_f32_32x32x16_bf16 v[8:23], v[80:83], a[32:35], v[8:23]
    ds_read_b128 a[40:43], v78
    ds_read_b128 a[44:47], v79
    ds_read_b64_tr_b16 v[48:49], v75 offset:20480
    ds_read_b64_tr_b16 v[50:51], v75 offset:20992
    s_add_u32 m0, s51, 73728
    s_nop 0
    buffer_load_dwordx4 v72, s[8:11], s48 offen lds
    s_add_u32 s47, s47, 128
    s_add_u32 s48, s48, 128
    v_mov_b32 v2, 256
    ds_read_b32 v3, v2
    s_waitcnt lgkmcnt(0)
    v_readfirstlane_b32 s82, v3
    s_waitcnt lgkmcnt(5)
    v_mfma_f32_32x32x16_bf16 v[8:23], v[40:43], a[36:39], v[8:23]
    ds_read_b64_tr_b16 v[80:81], v75 offset:22528
    ds_read_b64_tr_b16 v[82:83], v75 offset:23040
    s_add_u32 m0, s51, 81920
    s_nop 0
    buffer_load_dwordx4 v73, s[12:15], s49 offen offset:0 lds
    s_add_u32 s49, s49, 221184
    s_waitcnt lgkmcnt(3)
    v_mfma_f32_32x32x16_bf16 v[8:23], v[48:51], a[40:43], v[8:23]
    s_waitcnt lgkmcnt(0)
    s_cmp_lg_u32 s40, 3
    s_cbranch_scc1 parallel_sum__linear_kernel_hedgehog__dense_activation_squared_relu__prompt_kernel_o_41
    s_waitcnt vmcnt(6)
parallel_sum__linear_kernel_hedgehog__dense_activation_squared_relu__prompt_kernel_o_41:
    s_waitcnt vmcnt(5)
    s_waitcnt vmcnt(8)
    s_barrier
    v_add_u32 v76, 0x8000, v76
    v_add_u32 v77, 0x8000, v77
    v_add_u32 v78, 0x8000, v78
    v_add_u32 v79, 0x8000, v79
    ds_read_b128 a[48:51], v76
    v_add_u32 v75, 0x8000, v75
    ds_read_b64_tr_b16 v[40:41], v75 offset:16384
    ds_read_b64_tr_b16 v[42:43], v75 offset:16896
    v_mfma_f32_32x32x16_bf16 v[8:23], v[80:83], a[44:47], v[8:23]
    ds_read_b128 a[52:55], v77
    ds_read_b64_tr_b16 v[48:49], v75 offset:18432
    ds_read_b64_tr_b16 v[50:51], v75 offset:18944
    s_add_u32 m0, s51, 98304
    s_nop 0
    buffer_load_dwordx4 v72, s[8:11], s47 offen lds
    s_cmp_lg_u32 s40, 0
    s_cbranch_scc1 parallel_sum__linear_kernel_hedgehog__dense_activation_squared_relu__prompt_kernel_o_42
    s_lshl_b32 s54, s43, 7
    s_lshl_b32 s55, s44, 2
    s_add_u32 s54, s54, s55
    s_add_u32 s54, s54, 2048
    v_mov_b32 v2, s54
    v_mov_b32 v3, s82
    buffer_store_dword v3, v2, s[32:35], 0 offen sc1
parallel_sum__linear_kernel_hedgehog__dense_activation_squared_relu__prompt_kernel_o_42:
    s_waitcnt lgkmcnt(3)
    v_mfma_f32_32x32x16_bf16 v[8:23], v[40:43], a[48:51], v[8:23]
    ds_read_b128 a[56:59], v78
    ds_read_b128 a[60:63], v79
    ds_read_b64_tr_b16 v[80:81], v75 offset:20480
    ds_read_b64_tr_b16 v[82:83], v75 offset:20992
    s_add_u32 m0, s51, 106496
    s_nop 0
    buffer_load_dwordx4 v72, s[8:11], s48 offen lds
    s_add_u32 s47, s47, 128
    s_add_u32 s48, s48, 128
    s_waitcnt lgkmcnt(4)
    v_mfma_f32_32x32x16_bf16 v[8:23], v[48:51], a[52:55], v[8:23]
    ds_read_b64_tr_b16 v[40:41], v75 offset:22528
    ds_read_b64_tr_b16 v[42:43], v75 offset:23040
    s_add_u32 m0, s51, 114688
    s_nop 0
    buffer_load_dwordx4 v73, s[12:15], s49 offen offset:0 lds
    s_add_u32 s49, s49, 221184
    s_add_u32 s28, s66, 10485760
    s_addc_u32 s29, s67, 0
    s_mov_b32 s30, 3031040
    s_mov_b32 s31, 0x20000
    s_lshr_b32 s52, s83, 2
    s_mul_i32 s52, s52, 5120
    s_and_b32 s53, s83, 3
    s_lshl_b32 s53, s53, 8
    s_add_u32 s52, s52, s53
    s_lshl_b32 s53, s40, 2
    v_lshrrev_b32 v2, 4, v1
    v_add_u32 v2, s53, v2
    v_mul_u32_u24 v3, 205, v2
    v_lshrrev_b32 v3, 10, v3
    v_mul_u32_u24 v4, 5, v3
    v_sub_u32 v4, v2, v4
    v_mul_u32_u24 v5, 160, v3
    v_lshl_add_u32 v5, v4, 3, v5
    v_and_b32 v2, 3, v1
    v_mul_u32_u24 v2, 40, v2
    v_add_u32 v5, v5, v2
    v_lshrrev_b32 v2, 7, v5
    v_and_b32 v5, 127, v5
    v_lshl_add_u32 v5, v2, 10, v5
    v_bfe_u32 v2, v1, 2, 2
    v_lshl_add_u32 v5, v2, 7, v5
    ds_read_b64_tr_b16 v[56:57], v5 offset:8192
    ds_read_b64_tr_b16 v[58:59], v5 offset:8704
    v_mul_u32_u24 v3, 378880, v3
    v_lshl_add_u32 v3, v4, 10, v3
    v_and_b32 v2, 15, v1
    v_lshl_add_u32 v3, v2, 4, v3
    s_waitcnt lgkmcnt(0)
    buffer_store_dwordx4 v[56:59], v3, s[28:31], s52 offen sc1
    s_cmp_ge_u32 s40, 2
    s_cbranch_scc1 parallel_sum__linear_kernel_hedgehog__dense_activation_squared_relu__prompt_kernel_o_43
    s_lshl_b32 s53, s40, 2
    v_lshrrev_b32 v2, 4, v1
    v_add_u32 v2, s53, v2
    v_add_u32 v2, 32, v2
    v_mul_u32_u24 v3, 205, v2
    v_lshrrev_b32 v3, 10, v3
    v_mul_u32_u24 v4, 5, v3
    v_sub_u32 v4, v2, v4
    v_mul_u32_u24 v5, 160, v3
    v_lshl_add_u32 v5, v4, 3, v5
    v_and_b32 v2, 3, v1
    v_mul_u32_u24 v2, 40, v2
    v_add_u32 v5, v5, v2
    v_lshrrev_b32 v2, 7, v5
    v_and_b32 v5, 127, v5
    v_lshl_add_u32 v5, v2, 10, v5
    v_bfe_u32 v2, v1, 2, 2
    v_lshl_add_u32 v5, v2, 7, v5
    ds_read_b64_tr_b16 v[60:61], v5 offset:8192
    ds_read_b64_tr_b16 v[62:63], v5 offset:8704
    v_mul_u32_u24 v3, 378880, v3
    v_lshl_add_u32 v3, v4, 10, v3
    v_and_b32 v2, 15, v1
    v_lshl_add_u32 v3, v2, 4, v3
    s_waitcnt lgkmcnt(0)
    buffer_store_dwordx4 v[60:63], v3, s[28:31], s52 offen sc1
parallel_sum__linear_kernel_hedgehog__dense_activation_squared_relu__prompt_kernel_o_43:
    s_add_u32 s28, s66, 10485760
    s_addc_u32 s29, s67, 0
    s_mov_b32 s30, 3031040
    s_mov_b32 s31, 0x20000
    s_lshr_b32 s52, s84, 2
    s_mul_i32 s52, s52, 5120
    s_and_b32 s53, s84, 3
    s_lshl_b32 s53, s53, 8
    s_add_u32 s52, s52, s53
    s_lshl_b32 s53, s40, 2
    v_lshrrev_b32 v2, 4, v1
    v_add_u32 v2, s53, v2
    v_mul_u32_u24 v3, 205, v2
    v_lshrrev_b32 v3, 10, v3
    v_mul_u32_u24 v4, 5, v3
    v_sub_u32 v4, v2, v4
    v_mul_u32_u24 v5, 160, v3
    v_lshl_add_u32 v5, v4, 3, v5
    v_and_b32 v2, 3, v1
    v_mul_u32_u24 v2, 40, v2
    v_add_u32 v5, v5, v2
    v_lshrrev_b32 v2, 7, v5
    v_and_b32 v5, 127, v5
    v_lshl_add_u32 v5, v2, 10, v5
    v_bfe_u32 v2, v1, 2, 2
    v_lshl_add_u32 v5, v2, 7, v5
    ds_read_b64_tr_b16 v[64:65], v5 offset:18432
    ds_read_b64_tr_b16 v[66:67], v5 offset:18944
    v_mul_u32_u24 v3, 378880, v3
    v_lshl_add_u32 v3, v4, 10, v3
    v_and_b32 v2, 15, v1
    v_lshl_add_u32 v3, v2, 4, v3
    s_waitcnt lgkmcnt(0)
    buffer_store_dwordx4 v[64:67], v3, s[28:31], s52 offen sc1
    s_cmp_ge_u32 s40, 2
    s_cbranch_scc1 parallel_sum__linear_kernel_hedgehog__dense_activation_squared_relu__prompt_kernel_o_44
    s_lshl_b32 s53, s40, 2
    v_lshrrev_b32 v2, 4, v1
    v_add_u32 v2, s53, v2
    v_add_u32 v2, 32, v2
    v_mul_u32_u24 v3, 205, v2
    v_lshrrev_b32 v3, 10, v3
    v_mul_u32_u24 v4, 5, v3
    v_sub_u32 v4, v2, v4
    v_mul_u32_u24 v5, 160, v3
    v_lshl_add_u32 v5, v4, 3, v5
    v_and_b32 v2, 3, v1
    v_mul_u32_u24 v2, 40, v2
    v_add_u32 v5, v5, v2
    v_lshrrev_b32 v2, 7, v5
    v_and_b32 v5, 127, v5
    v_lshl_add_u32 v5, v2, 10, v5
    v_bfe_u32 v2, v1, 2, 2
    v_lshl_add_u32 v5, v2, 7, v5
    ds_read_b64_tr_b16 v[68:69], v5 offset:18432
    ds_read_b64_tr_b16 v[70:71], v5 offset:18944
    v_mul_u32_u24 v3, 378880, v3
    v_lshl_add_u32 v3, v4, 10, v3
    v_and_b32 v2, 15, v1
    v_lshl_add_u32 v3, v2, 4, v3
    s_waitcnt lgkmcnt(0)
    buffer_store_dwordx4 v[68:71], v3, s[28:31], s52 offen sc1
parallel_sum__linear_kernel_hedgehog__dense_activation_squared_relu__prompt_kernel_o_44:
    s_waitcnt lgkmcnt(6)
    v_mfma_f32_32x32x16_bf16 v[8:23], v[80:83], a[56:59], v[8:23]
    s_waitcnt lgkmcnt(4)
    s_waitcnt vmcnt(8)
    s_barrier
    v_subrev_u32 v76, 0x18000, v76
    v_subrev_u32 v77, 0x18000, v77
    v_subrev_u32 v78, 0x18000, v78
    v_subrev_u32 v79, 0x18000, v79
    ds_read_b128 a[64:67], v76
    v_subrev_u32 v75, 0x18000, v75
    ds_read_b64_tr_b16 v[48:49], v75 offset:16384
    ds_read_b64_tr_b16 v[50:51], v75 offset:16896
    v_mfma_f32_32x32x16_bf16 v[8:23], v[40:43], a[60:63], v[8:23]
    ds_read_b128 a[68:71], v77
    ds_read_b64_tr_b16 v[80:81], v75 offset:18432
    ds_read_b64_tr_b16 v[82:83], v75 offset:18944
    s_add_u32 m0, s51, 131072
    s_nop 0
    buffer_load_dwordx4 v72, s[8:11], s47 offen lds
    s_mul_i32 s83, s43, 5
    s_add_u32 s83, s83, s44
    s_add_u32 s83, s83, 1048725
    s_sub_u32 s83, s83, 1048576
    s_lshr_b32 s52, s83, 2
    s_and_b32 s53, s83, 3
    s_lshl_b32 s54, s52, 5
    s_and_b32 s55, s53, 1
    s_lshl_b32 s55, s55, 4
    s_add_u32 s54, s54, s55
    s_lshr_b32 s55, s53, 1
    s_lshl_b32 s55, s55, 2
    s_add_u32 s54, s54, s55
    s_add_u32 s55, s54, 8
    s_mov_b32 s28, s62
    s_mov_b32 s29, s63
    s_mov_b32 s30, 2211840
    s_mov_b32 s31, 0x20000
    s_cmp_lt_u32 s83, 216
    s_cbranch_scc1 parallel_sum__linear_kernel_hedgehog__dense_activation_squared_relu__prompt_kernel_po_45
    s_sub_u32 s52, s83, 216
    s_mul_i32 s53, s52, 205
    s_lshr_b32 s53, s53, 10
    s_mul_i32 s54, s53, 5
    s_sub_u32 s52, s52, s54
    s_mul_i32 s53, s53, 40
    s_lshl_b32 s52, s52, 3
    s_mov_b32 s54, 0x18140400
    s_mov_b32 s55, 0x10
    s_lshr_b64 s[54:55], s[54:55], s52
    s_and_b32 s54, s54, 0xff
    s_add_u32 s54, s54, s53
    s_add_u32 s55, s54, 8
    s_add_u32 s53, s53, 36
    s_cmp_eq_u32 s52, 32
    s_cselect_b32 s55, s53, s55
    s_mov_b32 s28, s64
    s_mov_b32 s29, s65
    s_mov_b32 s30, 819200
parallel_sum__linear_kernel_hedgehog__dense_activation_squared_relu__prompt_kernel_po_45:
    v_lshrrev_b32 v2, 3, v1
    s_sub_u32 s55, s55, 4
    v_add_u32 v3, s54, v2
    v_add_u32 v4, s55, v2
    v_cmp_gt_u32 vcc, 4, v2
    s_nop 1
    v_cndmask_b32 v3, v4, v3, vcc
    v_mul_u32_u24 v3, 1280, v3
    v_and_b32 v4, 7, v1
    v_lshl_add_u32 v3, v4, 4, v3
    s_lshl_b32 s52, s40, 7
    s_add_u32 m0, s51, 8192
    s_nop 0
    buffer_load_dwordx4 v3, s[28:31], s52 offen lds
    s_cmp_ge_u32 s40, 2
    s_cbranch_scc1 parallel_sum__linear_kernel_hedgehog__dense_activation_squared_relu__prompt_kernel_o_46
    s_add_u32 s52, s52, 1024
    s_add_u32 m0, s51, 16384
    s_nop 0
    buffer_load_dwordx4 v3, s[28:31], s52 offen lds
parallel_sum__linear_kernel_hedgehog__dense_activation_squared_relu__prompt_kernel_o_46:
    s_cmp_ge_u32 s83, 216
    s_cbranch_scc1 parallel_sum__linear_kernel_hedgehog__dense_activation_squared_relu__prompt_kernel_q4_47
    s_mul_i32 s84, s43, 5
    s_add_u32 s84, s84, s44
    s_add_u32 s84, s84, 1048805
    s_sub_u32 s84, s84, 1048576
    s_lshr_b32 s52, s84, 2
    s_and_b32 s53, s84, 3
    s_lshl_b32 s54, s52, 5
    s_and_b32 s55, s53, 1
    s_lshl_b32 s55, s55, 4
    s_add_u32 s54, s54, s55
    s_lshr_b32 s55, s53, 1
    s_lshl_b32 s55, s55, 2
    s_add_u32 s54, s54, s55
    s_add_u32 s55, s54, 8
    s_mov_b32 s28, s62
    s_mov_b32 s29, s63
    s_mov_b32 s30, 2211840
    s_mov_b32 s31, 0x20000
    s_cmp_lt_u32 s84, 216
    s_cbranch_scc1 parallel_sum__linear_kernel_hedgehog__dense_activation_squared_relu__prompt_kernel_po_48
    s_sub_u32 s52, s84, 216
    s_mul_i32 s53, s52, 205
    s_lshr_b32 s53, s53, 10
    s_mul_i32 s54, s53, 5
    s_sub_u32 s52, s52, s54
    s_mul_i32 s53, s53, 40
    s_lshl_b32 s52, s52, 3
    s_mov_b32 s54, 0x18140400
    s_mov_b32 s55, 0x10
    s_lshr_b64 s[54:55], s[54:55], s52
    s_and_b32 s54, s54, 0xff
    s_add_u32 s54, s54, s53
    s_add_u32 s55, s54, 8
    s_add_u32 s53, s53, 36
    s_cmp_eq_u32 s52, 32
    s_cselect_b32 s55, s53, s55
    s_mov_b32 s28, s64
    s_mov_b32 s29, s65
    s_mov_b32 s30, 819200
parallel_sum__linear_kernel_hedgehog__dense_activation_squared_relu__prompt_kernel_po_48:
    v_lshrrev_b32 v2, 3, v1
    s_sub_u32 s55, s55, 4
    v_add_u32 v3, s54, v2
    v_add_u32 v4, s55, v2
    v_cmp_gt_u32 vcc, 4, v2
    s_nop 1
    v_cndmask_b32 v3, v4, v3, vcc
    v_mul_u32_u24 v3, 1280, v3
    v_and_b32 v4, 7, v1
    v_lshl_add_u32 v3, v4, 4, v3
    s_lshl_b32 s52, s40, 7
    s_add_u32 m0, s51, 18432
    s_nop 0
    buffer_load_dwordx4 v3, s[28:31], s52 offen lds
    s_cmp_ge_u32 s40, 2
    s_cbranch_scc1 parallel_sum__linear_kernel_hedgehog__dense_activation_squared_relu__prompt_kernel_o_49
    s_add_u32 s52, s52, 1024
    s_add_u32 m0, s51, 26624
    s_nop 0
    buffer_load_dwordx4 v3, s[28:31], s52 offen lds
parallel_sum__linear_kernel_hedgehog__dense_activation_squared_relu__prompt_kernel_o_49:
parallel_sum__linear_kernel_hedgehog__dense_activation_squared_relu__prompt_kernel_q4_47:
    s_waitcnt lgkmcnt(3)
    v_mfma_f32_32x32x16_bf16 v[8:23], v[48:51], a[64:67], v[8:23]
    ds_read_b128 a[72:75], v78
    ds_read_b128 a[76:79], v79
    ds_read_b64_tr_b16 v[40:41], v75 offset:20480
    ds_read_b64_tr_b16 v[42:43], v75 offset:20992
    s_add_u32 m0, s51, 139264
    s_nop 0
    buffer_load_dwordx4 v72, s[8:11], s48 offen lds
    s_add_u32 s47, s47, 128
    s_add_u32 s48, s48, 128
    s_waitcnt lgkmcnt(4)
    v_mfma_f32_32x32x16_bf16 v[8:23], v[80:83], a[68:71], v[8:23]
    ds_read_b64_tr_b16 v[48:49], v75 offset:22528
    ds_read_b64_tr_b16 v[50:51], v75 offset:23040
    s_add_u32 m0, s51, 147456
    s_nop 0
    buffer_load_dwordx4 v73, s[12:15], s49 offen offset:0 lds
    s_add_u32 s49, s49, 221184
    s_waitcnt lgkmcnt(2)
    v_mfma_f32_32x32x16_bf16 v[8:23], v[40:43], a[72:75], v[8:23]
    s_waitcnt lgkmcnt(0)
    s_waitcnt vmcnt(9)
    s_barrier
    v_add_u32 v76, 0x8000, v76
    v_add_u32 v77, 0x8000, v77
    v_add_u32 v78, 0x8000, v78
    v_add_u32 v79, 0x8000, v79
    ds_read_b128 a[80:83], v76
    v_add_u32 v75, 0x8000, v75
    ds_read_b64_tr_b16 v[80:81], v75 offset:16384
    ds_read_b64_tr_b16 v[82:83], v75 offset:16896
    v_mfma_f32_32x32x16_bf16 v[8:23], v[48:51], a[76:79], v[8:23]
    ds_read_b128 a[84:87], v77
    ds_read_b64_tr_b16 v[40:41], v75 offset:18432
    ds_read_b64_tr_b16 v[42:43], v75 offset:18944
    s_add_u32 m0, s51, 32768
    s_nop 0
    buffer_load_dwordx4 v72, s[8:11], s47 offen lds
    s_waitcnt lgkmcnt(3)
    v_mfma_f32_32x32x16_bf16 v[8:23], v[80:83], a[80:83], v[8:23]
    ds_read_b128 a[88:91], v78
    ds_read_b128 a[92:95], v79
    ds_read_b64_tr_b16 v[48:49], v75 offset:20480
    ds_read_b64_tr_b16 v[50:51], v75 offset:20992
    s_add_u32 m0, s51, 40960
    s_nop 0
    buffer_load_dwordx4 v72, s[8:11], s48 offen lds
    s_add_u32 s47, s47, 128
    s_add_u32 s48, s48, 128
    v_and_b32 v2, 15, v1
    v_lshlrev_b32 v2, 2, v2
    s_lshl_b32 s54, s44, 7
    s_add_u32 s54, s54, 0
    s_lshl_b32 s55, s43, 7
    s_add_u32 s55, s55, 2048
    v_add_u32 v3, s54, v2
    v_add_u32 v2, s55, v2
    v_and_b32 v4, 16, v1
    v_cmp_eq_u32 vcc, 0, v4
    s_nop 1
    v_cndmask_b32 v88, v2, v3, vcc
    s_cmp_lg_u32 s40, 0
    s_cbranch_scc1 parallel_sum__linear_kernel_hedgehog__dense_activation_squared_relu__prompt_kernel_o_50
    buffer_load_dword v7, v88, s[32:35], 0 offen sc1
parallel_sum__linear_kernel_hedgehog__dense_activation_squared_relu__prompt_kernel_o_50:
    s_waitcnt lgkmcnt(4)
    v_mfma_f32_32x32x16_bf16 v[8:23], v[40:43], a[84:87], v[8:23]
    ds_read_b64_tr_b16 v[80:81], v75 offset:22528
    ds_read_b64_tr_b16 v[82:83], v75 offset:23040
    s_add_u32 m0, s51, 49152
    s_nop 0
    buffer_load_dwordx4 v73, s[12:15], s49 offen offset:0 lds
    s_add_u32 s49, s49, 221184
    s_waitcnt lgkmcnt(2)
    v_mfma_f32_32x32x16_bf16 v[8:23], v[48:51], a[88:91], v[8:23]
    s_waitcnt lgkmcnt(0)
    s_waitcnt vmcnt(4)
    s_waitcnt vmcnt(9)
    s_barrier
    v_add_u32 v76, 0x8000, v76
    v_add_u32 v77, 0x8000, v77
    v_add_u32 v78, 0x8000, v78
    v_add_u32 v79, 0x8000, v79
    ds_read_b128 a[96:99], v76
    v_add_u32 v75, 0x8000, v75
    ds_read_b64_tr_b16 v[40:41], v75 offset:16384
    ds_read_b64_tr_b16 v[42:43], v75 offset:16896
    v_mfma_f32_32x32x16_bf16 v[8:23], v[80:83], a[92:95], v[8:23]
    ds_read_b128 a[100:103], v77
    ds_read_b64_tr_b16 v[48:49], v75 offset:18432
    ds_read_b64_tr_b16 v[50:51], v75 offset:18944
    s_add_u32 m0, s51, 65536
    s_nop 0
    buffer_load_dwordx4 v72, s[8:11], s47 offen lds
    s_waitcnt lgkmcnt(3)
    v_mfma_f32_32x32x16_bf16 v[8:23], v[40:43], a[96:99], v[8:23]
    ds_read_b128 a[104:107], v78
    ds_read_b128 a[108:111], v79
    ds_read_b64_tr_b16 v[80:81], v75 offset:20480
    ds_read_b64_tr_b16 v[82:83], v75 offset:20992
    s_add_u32 m0, s51, 73728
    s_nop 0
    buffer_load_dwordx4 v72, s[8:11], s48 offen lds
    s_add_u32 s47, s47, 128
    s_add_u32 s48, s48, 128
    s_waitcnt lgkmcnt(4)
    v_mfma_f32_32x32x16_bf16 v[8:23], v[48:51], a[100:103], v[8:23]
    ds_read_b64_tr_b16 v[40:41], v75 offset:22528
    ds_read_b64_tr_b16 v[42:43], v75 offset:23040
    s_add_u32 m0, s51, 81920
    s_nop 0
    buffer_load_dwordx4 v73, s[12:15], s49 offen offset:0 lds
    s_add_u32 s49, s49, 221184
    s_add_u32 s28, s66, 10485760
    s_addc_u32 s29, s67, 0
    s_mov_b32 s30, 3031040
    s_mov_b32 s31, 0x20000
    s_lshr_b32 s52, s83, 2
    s_mul_i32 s52, s52, 5120
    s_and_b32 s53, s83, 3
    s_lshl_b32 s53, s53, 8
    s_add_u32 s52, s52, s53
    s_lshl_b32 s53, s40, 2
    v_lshrrev_b32 v2, 4, v1
    v_add_u32 v2, s53, v2
    v_mul_u32_u24 v3, 205, v2
    v_lshrrev_b32 v3, 10, v3
    v_mul_u32_u24 v4, 5, v3
    v_sub_u32 v4, v2, v4
    v_mul_u32_u24 v5, 160, v3
    v_lshl_add_u32 v5, v4, 3, v5
    v_and_b32 v2, 3, v1
    v_mul_u32_u24 v2, 40, v2
    v_add_u32 v5, v5, v2
    v_lshrrev_b32 v2, 7, v5
    v_and_b32 v5, 127, v5
    v_lshl_add_u32 v5, v2, 10, v5
    v_bfe_u32 v2, v1, 2, 2
    v_lshl_add_u32 v5, v2, 7, v5
    ds_read_b64_tr_b16 v[56:57], v5 offset:8192
    ds_read_b64_tr_b16 v[58:59], v5 offset:8704
    v_mul_u32_u24 v3, 378880, v3
    v_lshl_add_u32 v3, v4, 10, v3
    v_and_b32 v2, 15, v1
    v_lshl_add_u32 v3, v2, 4, v3
    s_waitcnt lgkmcnt(0)
    buffer_store_dwordx4 v[56:59], v3, s[28:31], s52 offen sc1
    s_cmp_ge_u32 s40, 2
    s_cbranch_scc1 parallel_sum__linear_kernel_hedgehog__dense_activation_squared_relu__prompt_kernel_o_51
    s_lshl_b32 s53, s40, 2
    v_lshrrev_b32 v2, 4, v1
    v_add_u32 v2, s53, v2
    v_add_u32 v2, 32, v2
    v_mul_u32_u24 v3, 205, v2
    v_lshrrev_b32 v3, 10, v3
    v_mul_u32_u24 v4, 5, v3
    v_sub_u32 v4, v2, v4
    v_mul_u32_u24 v5, 160, v3
    v_lshl_add_u32 v5, v4, 3, v5
    v_and_b32 v2, 3, v1
    v_mul_u32_u24 v2, 40, v2
    v_add_u32 v5, v5, v2
    v_lshrrev_b32 v2, 7, v5
    v_and_b32 v5, 127, v5
    v_lshl_add_u32 v5, v2, 10, v5
    v_bfe_u32 v2, v1, 2, 2
    v_lshl_add_u32 v5, v2, 7, v5
    ds_read_b64_tr_b16 v[60:61], v5 offset:8192
    ds_read_b64_tr_b16 v[62:63], v5 offset:8704
    v_mul_u32_u24 v3, 378880, v3
    v_lshl_add_u32 v3, v4, 10, v3
    v_and_b32 v2, 15, v1
    v_lshl_add_u32 v3, v2, 4, v3
    s_waitcnt lgkmcnt(0)
    buffer_store_dwordx4 v[60:63], v3, s[28:31], s52 offen sc1
parallel_sum__linear_kernel_hedgehog__dense_activation_squared_relu__prompt_kernel_o_51:
    s_cmp_ge_u32 s83, 216
    s_cbranch_scc1 parallel_sum__linear_kernel_hedgehog__dense_activation_squared_relu__prompt_kernel_q5_52
    s_add_u32 s28, s66, 10485760
    s_addc_u32 s29, s67, 0
    s_mov_b32 s30, 3031040
    s_mov_b32 s31, 0x20000
    s_lshr_b32 s52, s84, 2
    s_mul_i32 s52, s52, 5120
    s_and_b32 s53, s84, 3
    s_lshl_b32 s53, s53, 8
    s_add_u32 s52, s52, s53
    s_lshl_b32 s53, s40, 2
    v_lshrrev_b32 v2, 4, v1
    v_add_u32 v2, s53, v2
    v_mul_u32_u24 v3, 205, v2
    v_lshrrev_b32 v3, 10, v3
    v_mul_u32_u24 v4, 5, v3
    v_sub_u32 v4, v2, v4
    v_mul_u32_u24 v5, 160, v3
    v_lshl_add_u32 v5, v4, 3, v5
    v_and_b32 v2, 3, v1
    v_mul_u32_u24 v2, 40, v2
    v_add_u32 v5, v5, v2
    v_lshrrev_b32 v2, 7, v5
    v_and_b32 v5, 127, v5
    v_lshl_add_u32 v5, v2, 10, v5
    v_bfe_u32 v2, v1, 2, 2
    v_lshl_add_u32 v5, v2, 7, v5
    ds_read_b64_tr_b16 v[64:65], v5 offset:18432
    ds_read_b64_tr_b16 v[66:67], v5 offset:18944
    v_mul_u32_u24 v3, 378880, v3
    v_lshl_add_u32 v3, v4, 10, v3
    v_and_b32 v2, 15, v1
    v_lshl_add_u32 v3, v2, 4, v3
    s_waitcnt lgkmcnt(0)
    buffer_store_dwordx4 v[64:67], v3, s[28:31], s52 offen sc1
    s_cmp_ge_u32 s40, 2
    s_cbranch_scc1 parallel_sum__linear_kernel_hedgehog__dense_activation_squared_relu__prompt_kernel_o_53
    s_lshl_b32 s53, s40, 2
    v_lshrrev_b32 v2, 4, v1
    v_add_u32 v2, s53, v2
    v_add_u32 v2, 32, v2
    v_mul_u32_u24 v3, 205, v2
    v_lshrrev_b32 v3, 10, v3
    v_mul_u32_u24 v4, 5, v3
    v_sub_u32 v4, v2, v4
    v_mul_u32_u24 v5, 160, v3
    v_lshl_add_u32 v5, v4, 3, v5
    v_and_b32 v2, 3, v1
    v_mul_u32_u24 v2, 40, v2
    v_add_u32 v5, v5, v2
    v_lshrrev_b32 v2, 7, v5
    v_and_b32 v5, 127, v5
    v_lshl_add_u32 v5, v2, 10, v5
    v_bfe_u32 v2, v1, 2, 2
    v_lshl_add_u32 v5, v2, 7, v5
    ds_read_b64_tr_b16 v[68:69], v5 offset:18432
    ds_read_b64_tr_b16 v[70:71], v5 offset:18944
    v_mul_u32_u24 v3, 378880, v3
    v_lshl_add_u32 v3, v4, 10, v3
    v_and_b32 v2, 15, v1
    v_lshl_add_u32 v3, v2, 4, v3
    s_waitcnt lgkmcnt(0)
    buffer_store_dwordx4 v[68:71], v3, s[28:31], s52 offen sc1
parallel_sum__linear_kernel_hedgehog__dense_activation_squared_relu__prompt_kernel_o_53:
parallel_sum__linear_kernel_hedgehog__dense_activation_squared_relu__prompt_kernel_q5_52:
    s_waitcnt lgkmcnt(4)
    v_mfma_f32_32x32x16_bf16 v[8:23], v[80:83], a[104:107], v[8:23]
    s_waitcnt lgkmcnt(2)
    s_cmp_lg_u32 s40, 0
    s_cbranch_scc1 parallel_sum__linear_kernel_hedgehog__dense_activation_squared_relu__prompt_kernel_o_54
    s_waitcnt vmcnt(5)
    s_mov_b32 s52, 0x40000
parallel_sum__linear_kernel_hedgehog__dense_activation_squared_relu__prompt_kernel_sp_55:
    v_cmp_ne_u32 vcc, s82, v7
    s_nop 4
    s_cbranch_vccz parallel_sum__linear_kernel_hedgehog__dense_activation_squared_relu__prompt_kernel_sd_56
    s_sub_u32 s52, s52, 1
    s_cmp_eq_u32 s52, 0
    s_cbranch_scc1 parallel_sum__linear_kernel_hedgehog__dense_activation_squared_relu__prompt_kernel_sd_56
    s_sleep 8
    buffer_load_dword v7, v88, s[32:35], 0 offen sc1
    s_waitcnt vmcnt(0)
    s_branch parallel_sum__linear_kernel_hedgehog__dense_activation_squared_relu__prompt_kernel_sp_55
parallel_sum__linear_kernel_hedgehog__dense_activation_squared_relu__prompt_kernel_sd_56:
parallel_sum__linear_kernel_hedgehog__dense_activation_squared_relu__prompt_kernel_o_54:
    s_waitcnt vmcnt(7)
    s_barrier
    v_add_u32 v76, 0x8000, v76
    v_add_u32 v77, 0x8000, v77
    v_add_u32 v78, 0x8000, v78
    v_add_u32 v79, 0x8000, v79
    ds_read_b128 a[112:115], v76
    v_add_u32 v75, 0x8000, v75
    ds_read_b64_tr_b16 v[48:49], v75 offset:16384
    ds_read_b64_tr_b16 v[50:51], v75 offset:16896
    v_mfma_f32_32x32x16_bf16 v[8:23], v[40:43], a[108:111], v[8:23]
    ds_read_b128 a[116:119], v77
    ds_read_b64_tr_b16 v[80:81], v75 offset:18432
    ds_read_b64_tr_b16 v[82:83], v75 offset:18944
    s_add_u32 m0, s51, 98304
    s_nop 0
    buffer_load_dwordx4 v74, s[36:39], s50 offen sc1 lds
    s_add_u32 s50, s50, 8192
    s_lshl_b32 s54, s44, 14
    s_add_u32 s54, s54, s51
    s_add_u32 s54, s54, 3211264
    s_add_u32 m0, s51, 8192
    s_nop 0
    buffer_load_dwordx4 v74, s[36:39], s54 offen sc1 lds
    s_add_u32 s54, s54, 8192
    s_add_u32 m0, s51, 16384
    s_nop 0
    buffer_load_dwordx4 v74, s[36:39], s54 offen sc1 lds
    v_and_b32 v2, 31, v1
    s_lshl_b32 s54, s43, 7
    s_lshl_b32 s55, s41, 5
    s_add_u32 s54, s54, s55
    v_add_u32 v2, s54, v2
    v_lshlrev_b32 v2, 3, v2
    s_mov_b32 s54, 3145728
    buffer_load_dwordx2 v[94:95], v2, s[36:39], s54 offen sc1
    s_waitcnt lgkmcnt(3)
    v_mfma_f32_32x32x16_bf16 v[8:23], v[48:51], a[112:115], v[8:23]
    ds_read_b128 a[120:123], v78
    ds_read_b128 a[124:127], v79
    ds_read_b64_tr_b16 v[40:41], v75 offset:20480
    ds_read_b64_tr_b16 v[42:43], v75 offset:20992
    s_add_u32 m0, s51, 106496
    s_nop 0
    buffer_load_dwordx4 v74, s[36:39], s50 offen sc1 lds
    s_add_u32 s50, s50, 8192
    s_waitcnt lgkmcnt(4)
    v_mfma_f32_32x32x16_bf16 v[8:23], v[80:83], a[116:119], v[8:23]
    ds_read_b64_tr_b16 v[48:49], v75 offset:22528
    ds_read_b64_tr_b16 v[50:51], v75 offset:23040
    s_add_u32 m0, s51, 114688
    s_nop 0
    buffer_load_dwordx4 v74, s[36:39], s50 offen sc1 lds
    s_add_u32 s50, s50, 8192
    s_waitcnt lgkmcnt(2)
    v_mfma_f32_32x32x16_bf16 v[8:23], v[40:43], a[120:123], v[8:23]
    s_add_u32 m0, s51, 122880
    s_nop 0
    buffer_load_dwordx4 v74, s[36:39], s50 offen sc1 lds
    s_add_u32 s50, s50, 8192
    s_waitcnt lgkmcnt(0)
    s_waitcnt vmcnt(11)
    s_barrier
    v_subrev_u32 v76, 0x18000, v76
    v_subrev_u32 v77, 0x18000, v77
    v_subrev_u32 v78, 0x18000, v78
    v_subrev_u32 v79, 0x18000, v79
    ds_read_b128 a[128:131], v76
    v_subrev_u32 v75, 0x18000, v75
    ds_read_b64_tr_b16 v[80:81], v75 offset:16384
    ds_read_b64_tr_b16 v[82:83], v75 offset:16896
    v_mfma_f32_32x32x16_bf16 v[8:23], v[48:51], a[124:127], v[8:23]
    ds_read_b128 a[132:135], v77
    ds_read_b64_tr_b16 v[40:41], v75 offset:18432
    ds_read_b64_tr_b16 v[42:43], v75 offset:18944
    s_add_u32 m0, s51, 131072
    s_nop 0
    buffer_load_dwordx4 v74, s[36:39], s50 offen sc1 lds
    s_add_u32 s50, s50, 8192
    s_waitcnt lgkmcnt(3)
    v_mfma_f32_32x32x16_bf16 v[8:23], v[80:83], a[128:131], v[8:23]
    ds_read_b128 a[136:139], v78
    ds_read_b128 a[140:143], v79
    ds_read_b64_tr_b16 v[48:49], v75 offset:20480
    ds_read_b64_tr_b16 v[50:51], v75 offset:20992
    s_add_u32 m0, s51, 139264
    s_nop 0
    buffer_load_dwordx4 v74, s[36:39], s50 offen sc1 lds
    s_add_u32 s50, s50, 8192
    s_waitcnt lgkmcnt(4)
    v_mfma_f32_32x32x16_bf16 v[8:23], v[40:43], a[132:135], v[8:23]
    ds_read_b64_tr_b16 v[80:81], v75 offset:22528
    ds_read_b64_tr_b16 v[82:83], v75 offset:23040
    s_add_u32 m0, s51, 147456
    s_nop 0
    buffer_load_dwordx4 v74, s[36:39], s50 offen sc1 lds
    s_add_u32 s50, s50, 8192
    s_waitcnt lgkmcnt(2)
    v_mfma_f32_32x32x16_bf16 v[8:23], v[48:51], a[136:139], v[8:23]
    s_add_u32 m0, s51, 155648
    s_nop 0
    buffer_load_dwordx4 v74, s[36:39], s50 offen sc1 lds
    s_add_u32 s50, s50, 8192
    s_waitcnt lgkmcnt(0)
    s_waitcnt vmcnt(11)
    s_waitcnt vmcnt(7)
    s_waitcnt vmcnt(12)
    s_barrier
    v_add_u32 v76, 0x8000, v76
    v_add_u32 v77, 0x8000, v77
    v_add_u32 v78, 0x8000, v78
    v_add_u32 v79, 0x8000, v79
    ds_read_b128 a[144:147], v76
    v_add_u32 v75, 0x8000, v75
    ds_read_b64_tr_b16 v[40:41], v75 offset:16384
    ds_read_b64_tr_b16 v[42:43], v75 offset:16896
    v_mfma_f32_32x32x16_bf16 v[8:23], v[80:83], a[140:143], v[8:23]
    ds_read_b128 a[148:151], v77
    ds_read_b64_tr_b16 v[48:49], v75 offset:18432
    ds_read_b64_tr_b16 v[50:51], v75 offset:18944
    s_add_u32 m0, s51, 32768
    s_nop 0
    buffer_load_dwordx4 v74, s[36:39], s50 offen sc1 lds
    s_add_u32 s50, s50, 8192
    s_cmp_lg_u32 s40, 0
    s_cbranch_scc1 parallel_sum__linear_kernel_hedgehog__dense_activation_squared_relu__prompt_kernel_o_57
    s_lshl_b32 s54, s2, 2
    s_add_u32 s54, s54, 4096
    v_mov_b32 v2, s54
    v_mov_b32 v3, s82
    buffer_store_dword v3, v2, s[32:35], 0 offen sc1
parallel_sum__linear_kernel_hedgehog__dense_activation_squared_relu__prompt_kernel_o_57:
    s_waitcnt lgkmcnt(3)
    v_mfma_f32_32x32x16_bf16 v[8:23], v[40:43], a[144:147], v[8:23]
    ds_read_b128 a[152:155], v78
    ds_read_b128 a[156:159], v79
    ds_read_b64_tr_b16 v[80:81], v75 offset:20480
    ds_read_b64_tr_b16 v[82:83], v75 offset:20992
    s_add_u32 m0, s51, 40960
    s_nop 0
    buffer_load_dwordx4 v74, s[36:39], s50 offen sc1 lds
    s_add_u32 s50, s50, 8192
    v_rsq_f32 v76, v95
    v_sqrt_f32 v88, v95
    v_cvt_pk_bf16_f32 v64, v94, v94
    v_and_b32 v67, 0xffff0000, v64
    v_sub_f32 v67, v94, v67
    v_cvt_pk_bf16_f32 v65, v67, v67
    v_and_b32 v66, 0xffff0000, v65
    v_sub_f32 v67, v67, v66
    v_cvt_pk_bf16_f32 v66, v67, v67
    v_cvt_pk_bf16_f32 v68, v88, v88
    v_and_b32 v71, 0xffff0000, v68
    v_sub_f32 v71, v88, v71
    v_cvt_pk_bf16_f32 v69, v71, v71
    v_and_b32 v70, 0xffff0000, v69
    v_sub_f32 v71, v71, v70
    v_cvt_pk_bf16_f32 v70, v71, v71
    v_bfi_b32 v92, s87, v64, v65
    v_bfi_b32 v93, s87, v64, v66
    v_bfi_b32 v94, s87, v65, v64
    v_bfi_b32 v95, s87, v68, v69
    v_and_b32 v70, s87, v70
    v_mov_b32 v71, 0
    v_cndmask_b32 v92, v92, v70, s[80:81]
    v_cndmask_b32 v93, v93, v71, s[80:81]
    v_cndmask_b32 v94, v94, v71, s[80:81]
    v_cndmask_b32 v95, v95, v71, s[80:81]
    v_mul_f32 v78, v76, v76
    v_mul_f32 v77, 0x3fb8aa3b, v76
    v_mov_b32 v79, v78
    v_and_b32 v2, 31, v1
    s_lshl_b32 s54, s42, 5
    v_add_u32 v2, s54, v2
    v_lshlrev_b32 v91, 2, v2
    v_lshlrev_b32 v90, 1, v2
    s_waitcnt lgkmcnt(4)
    v_mfma_f32_32x32x16_bf16 v[8:23], v[48:51], a[148:151], v[8:23]
    ds_read_b64_tr_b16 v[40:41], v75 offset:22528
    ds_read_b64_tr_b16 v[42:43], v75 offset:23040
    s_add_u32 m0, s51, 49152
    s_nop 0
    buffer_load_dwordx4 v74, s[36:39], s50 offen sc1 lds
    s_add_u32 s50, s50, 8192
    v_add_u32 v5, 8192, v91
    ds_read2st64_b32 v[64:65], v5 offset0:0 offset1:4
    ds_read2st64_b32 v[66:67], v5 offset0:8 offset1:12
    ds_read2st64_b32 v[68:69], v5 offset0:16 offset1:20
    ds_read2st64_b32 v[70:71], v5 offset0:24 offset1:28
    ds_read_u16 v89, v90 offset:0
    s_waitcnt lgkmcnt(1)
    v_pk_add_f32 v[64:65], v[64:65], v[66:67]
    v_pk_add_f32 v[68:69], v[68:69], v[70:71]
    v_pk_add_f32 v[64:65], v[64:65], v[68:69]
    v_add_f32 v88, v64, v65
    ds_read2st64_b32 v[64:65], v5 offset0:32 offset1:36
    ds_read2st64_b32 v[66:67], v5 offset0:40 offset1:44
    ds_read2st64_b32 v[68:69], v5 offset0:48 offset1:52
    ds_read2st64_b32 v[70:71], v5 offset0:56 offset1:60
    s_waitcnt lgkmcnt(0)
    v_pk_add_f32 v[64:65], v[64:65], v[66:67]
    v_pk_add_f32 v[68:69], v[68:69], v[70:71]
    v_pk_add_f32 v[64:65], v[64:65], v[68:69]
    v_add_f32 v64, v64, v65
    v_add_f32 v88, v88, v64
    v_cvt_pk_bf16_f32 v64, v88, v88
    v_and_b32 v67, 0xffff0000, v64
    v_sub_f32 v67, v88, v67
    v_cvt_pk_bf16_f32 v65, v67, v67
    v_and_b32 v66, 0xffff0000, v65
    v_sub_f32 v67, v67, v66
    v_cvt_pk_bf16_f32 v66, v67, v67
    v_bfi_b32 v57, s87, v65, v64
    v_bfi_b32 v58, s87, v65, v66
    v_mov_b32 v67, 0
    s_waitcnt lgkmcnt(4)
    v_lshl_or_b32 v59, v89, 16, v89
    v_cndmask_b32 v56, v64, v89, s[80:81]
    v_cndmask_b32 v59, v59, v67, s[80:81]
    v_cndmask_b32 v57, v57, v67, s[80:81]
    v_cndmask_b32 v58, v58, v67, s[80:81]
    s_waitcnt lgkmcnt(11)
    v_mfma_f32_32x32x16_bf16 v[8:23], v[80:83], a[152:155], v[8:23]
    s_add_u32 m0, s51, 57344
    s_nop 0
    buffer_load_dwordx4 v74, s[36:39], s50 offen sc1 lds
    s_add_u32 s50, s50, 8192
    s_waitcnt lgkmcnt(9)
    s_waitcnt vmcnt(8)
    s_barrier
    v_mfma_f32_32x32x16_bf16 v[8:23], v[40:43], a[156:159], v[8:23]
    s_add_u32 m0, s51, 65536
    s_nop 0
    buffer_load_dwordx4 v74, s[36:39], s50 offen sc1 lds
    s_add_u32 s50, s50, 8192
    s_add_u32 m0, s51, 73728
    s_nop 0
    buffer_load_dwordx4 v74, s[36:39], s50 offen sc1 lds
    s_add_u32 s50, s50, 8192
    s_add_u32 m0, s51, 81920
    s_nop 0
    buffer_load_dwordx4 v74, s[36:39], s50 offen sc1 lds
    s_add_u32 s50, s50, 8192
    s_add_u32 m0, s51, 90112
    s_nop 0
    buffer_load_dwordx4 v74, s[36:39], s50 offen sc1 lds
    s_add_u32 s50, s50, 8192
    v_mfma_f32_32x32x16_bf16 v[8:23], v[56:59], v[92:95], v[8:23]
    s_lshl_b32 s54, s43, 1
    s_lshr_b32 s55, s41, 1
    s_add_u32 s54, s54, s55
    s_mul_i32 s54, s54, 74
    s_lshl_b32 s55, s46, 1
    s_add_u32 s54, s54, s55
    s_add_u32 s54, s54, s42
    s_lshl_b32 s54, s54, 12
    s_and_b32 s55, s41, 1
    s_lshl_b32 s55, s55, 11
    s_add_u32 s54, s54, s55
    v_bfe_u32 v2, v1, 4, 1
    v_lshlrev_b32 v90, 10, v2
    v_lshl_add_u32 v90, v6, 9, v90
    v_and_b32 v2, 15, v1
    v_lshl_add_u32 v90, v2, 4, v90
    v_max_f32 v8, 0, v8
    v_max_f32 v9, 0, v9
    v_max_f32 v10, 0, v10
    v_max_f32 v11, 0, v11
    v_max_f32 v12, 0, v12
    v_max_f32 v13, 0, v13
    v_max_f32 v14, 0, v14
    v_max_f32 v15, 0, v15
    v_max_f32 v16, 0, v16
    v_max_f32 v17, 0, v17
    v_max_f32 v18, 0, v18
    v_max_f32 v19, 0, v19
    v_max_f32 v20, 0, v20
    v_max_f32 v21, 0, v21
    v_max_f32 v22, 0, v22
    v_max_f32 v23, 0, v23
    v_pk_mul_f32 v[8:9], v[8:9], v[8:9]
    v_pk_mul_f32 v[10:11], v[10:11], v[10:11]
    v_pk_mul_f32 v[12:13], v[12:13], v[12:13]
    v_pk_mul_f32 v[14:15], v[14:15], v[14:15]
    v_pk_mul_f32 v[16:17], v[16:17], v[16:17]
    v_pk_mul_f32 v[18:19], v[18:19], v[18:19]
    v_pk_mul_f32 v[20:21], v[20:21], v[20:21]
    v_pk_mul_f32 v[22:23], v[22:23], v[22:23]
    v_pk_mul_f32 v[8:9], v[8:9], v[78:79]
    v_pk_mul_f32 v[10:11], v[10:11], v[78:79]
    v_pk_mul_f32 v[12:13], v[12:13], v[78:79]
    v_pk_mul_f32 v[14:15], v[14:15], v[78:79]
    v_pk_mul_f32 v[16:17], v[16:17], v[78:79]
    v_pk_mul_f32 v[18:19], v[18:19], v[78:79]
    v_pk_mul_f32 v[20:21], v[20:21], v[78:79]
    v_pk_mul_f32 v[22:23], v[22:23], v[78:79]
    v_cvt_pk_bf16_f32 v8, v8, v9
    v_cvt_pk_bf16_f32 v9, v10, v11
    v_cvt_pk_bf16_f32 v10, v12, v13
    v_cvt_pk_bf16_f32 v11, v14, v15
    v_cvt_pk_bf16_f32 v12, v16, v17
    v_cvt_pk_bf16_f32 v13, v18, v19
    v_cvt_pk_bf16_f32 v14, v20, v21
    v_cvt_pk_bf16_f32 v15, v22, v23
    buffer_store_dwordx4 v[8:11], v90, s[16:19], s54 offen offset:0 sc1
    buffer_store_dwordx4 v[12:15], v90, s[16:19], s54 offen offset:256 sc1
parallel_sum__linear_kernel_hedgehog__dense_activation_squared_relu__prompt_kernel_joinA:
    s_lshl_b32 s54, s42, 11
    s_add_u32 s54, s54, 98304
    v_add_u32 v75, s54, v74
    ds_read_b128 v[40:43], v75 offset:0
    ds_read_b128 v[44:47], v75 offset:1024
    ds_read_b128 v[48:51], v75 offset:4096
    ds_read_b128 v[52:55], v75 offset:5120
    s_waitcnt lgkmcnt(2)
    v_mfma_f32_32x32x16_bf16 v[8:23], v[40:43], a[0:3], 0
    ds_read_b128 v[80:83], v75 offset:8192
    v_mfma_f32_32x32x16_bf16 v[24:39], v[44:47], a[0:3], 0
    ds_read_b128 v[84:87], v75 offset:9216
    s_waitcnt lgkmcnt(2)
    v_mfma_f32_32x32x16_bf16 v[8:23], v[48:51], a[4:7], v[8:23]
    ds_read_b128 v[40:43], v75 offset:12288
    v_mfma_f32_32x32x16_bf16 v[24:39], v[52:55], a[4:7], v[24:39]
    ds_read_b128 v[44:47], v75 offset:13312
    v_and_b32 v2, 31, v1
    s_lshl_b32 s54, s42, 6
    v_add_u32 v2, s54, v2
    v_lshlrev_b32 v91, 2, v2
    v_add_u32 v5, 8704, v91
    ds_read2st64_b32 v[64:65], v5 offset0:0 offset1:4
    ds_read2st64_b32 v[66:67], v5 offset0:8 offset1:12
    ds_read2st64_b32 v[68:69], v5 offset0:16 offset1:20
    ds_read2st64_b32 v[70:71], v5 offset0:24 offset1:28
    s_waitcnt lgkmcnt(0)
    v_pk_add_f32 v[64:65], v[64:65], v[66:67]
    v_pk_add_f32 v[68:69], v[68:69], v[70:71]
    v_pk_add_f32 v[64:65], v[64:65], v[68:69]
    v_add_f32 v88, v64, v65
    ds_read2st64_b32 v[64:65], v5 offset0:32 offset1:36
    ds_read2st64_b32 v[66:67], v5 offset0:40 offset1:44
    ds_read2st64_b32 v[68:69], v5 offset0:48 offset1:52
    ds_read2st64_b32 v[70:71], v5 offset0:56 offset1:60
    s_waitcnt lgkmcnt(0)
    v_pk_add_f32 v[64:65], v[64:65], v[66:67]
    v_pk_add_f32 v[68:69], v[68:69], v[70:71]
    v_pk_add_f32 v[64:65], v[64:65], v[68:69]
    v_add_f32 v64, v64, v65
    v_add_f32 v88, v88, v64
    v_cvt_pk_bf16_f32 v64, v88, v88
    v_and_b32 v67, 0xffff0000, v64
    v_sub_f32 v67, v88, v67
    v_cvt_pk_bf16_f32 v65, v67, v67
    v_and_b32 v66, 0xffff0000, v65
    v_sub_f32 v67, v67, v66
    v_cvt_pk_bf16_f32 v66, v67, v67
    v_bfi_b32 v57, s87, v65, v64
    v_bfi_b32 v58, s87, v65, v66
    v_mov_b32 v67, 0
    v_mov_b32 v59, 0
    v_cndmask_b32 v56, v64, v67, s[80:81]
    v_cndmask_b32 v57, v57, v67, s[80:81]
    v_cndmask_b32 v58, v58, v67, s[80:81]
    s_waitcnt lgkmcnt(10)
    v_mfma_f32_32x32x16_bf16 v[8:23], v[80:83], a[8:11], v[8:23]
    ds_read_b128 v[48:51], v75 offset:16384
    v_mfma_f32_32x32x16_bf16 v[24:39], v[84:87], a[8:11], v[24:39]
    ds_read_b128 v[52:55], v75 offset:17408
    s_waitcnt lgkmcnt(10)
    v_mfma_f32_32x32x16_bf16 v[8:23], v[40:43], a[12:15], v[8:23]
    ds_read_b128 v[80:83], v75 offset:20480
    v_mfma_f32_32x32x16_bf16 v[24:39], v[44:47], a[12:15], v[24:39]
    ds_read_b128 v[84:87], v75 offset:21504
    v_add_u32 v5, 8832, v91
    ds_read2st64_b32 v[64:65], v5 offset0:0 offset1:4
    ds_read2st64_b32 v[66:67], v5 offset0:8 offset1:12
    ds_read2st64_b32 v[68:69], v5 offset0:16 offset1:20
    ds_read2st64_b32 v[70:71], v5 offset0:24 offset1:28
    s_waitcnt lgkmcnt(0)
    v_pk_add_f32 v[64:65], v[64:65], v[66:67]
    v_pk_add_f32 v[68:69], v[68:69], v[70:71]
    v_pk_add_f32 v[64:65], v[64:65], v[68:69]
    v_add_f32 v88, v64, v65
    ds_read2st64_b32 v[64:65], v5 offset0:32 offset1:36
    ds_read2st64_b32 v[66:67], v5 offset0:40 offset1:44
    ds_read2st64_b32 v[68:69], v5 offset0:48 offset1:52
    ds_read2st64_b32 v[70:71], v5 offset0:56 offset1:60
    s_waitcnt lgkmcnt(0)
    v_pk_add_f32 v[64:65], v[64:65], v[66:67]
    v_pk_add_f32 v[68:69], v[68:69], v[70:71]
    v_pk_add_f32 v[64:65], v[64:65], v[68:69]
    v_add_f32 v64, v64, v65
    v_add_f32 v88, v88, v64
    v_cvt_pk_bf16_f32 v64, v88, v88
    v_and_b32 v67, 0xffff0000, v64
    v_sub_f32 v67, v88, v67
    v_cvt_pk_bf16_f32 v65, v67, v67
    v_and_b32 v66, 0xffff0000, v65
    v_sub_f32 v67, v67, v66
    v_cvt_pk_bf16_f32 v66, v67, v67
    v_bfi_b32 v61, s87, v65, v64
    v_bfi_b32 v62, s87, v65, v66
    v_mov_b32 v67, 0
    v_mov_b32 v63, 0
    v_cndmask_b32 v60, v64, v67, s[80:81]
    v_cndmask_b32 v61, v61, v67, s[80:81]
    v_cndmask_b32 v62, v62, v67, s[80:81]
    s_waitcnt lgkmcnt(10)
    v_mfma_f32_32x32x16_bf16 v[8:23], v[48:51], a[16:19], v[8:23]
    ds_read_b128 v[40:43], v75 offset:24576
    v_mfma_f32_32x32x16_bf16 v[24:39], v[52:55], a[16:19], v[24:39]
    ds_read_b128 v[44:47], v75 offset:25600
    s_waitcnt lgkmcnt(10)
    v_mfma_f32_32x32x16_bf16 v[8:23], v[80:83], a[20:23], v[8:23]
    ds_read_b128 v[48:51], v75 offset:28672
    v_mfma_f32_32x32x16_bf16 v[24:39], v[84:87], a[20:23], v[24:39]
    ds_read_b128 v[52:55], v75 offset:29696
    s_waitcnt lgkmcnt(2)
    v_mfma_f32_32x32x16_bf16 v[8:23], v[40:43], a[24:27], v[8:23]
    v_mfma_f32_32x32x16_bf16 v[24:39], v[44:47], a[24:27], v[24:39]
    s_waitcnt lgkmcnt(0)
    s_waitcnt vmcnt(10)
    s_barrier
    v_add_u32 v75, 0x8000, v75
    ds_read_b128 v[80:83], v75 offset:0
    ds_read_b128 v[84:87], v75 offset:1024
    v_mfma_f32_32x32x16_bf16 v[8:23], v[48:51], a[28:31], v[8:23]
    ds_read_b128 v[40:43], v75 offset:4096
    ds_read_b128 v[44:47], v75 offset:5120
    v_mfma_f32_32x32x16_bf16 v[24:39], v[52:55], a[28:31], v[24:39]
    s_add_u32 m0, s51, 98304
    s_nop 0
    buffer_load_dwordx4 v74, s[36:39], s50 offen sc1 lds
    s_add_u32 s50, s50, 8192
    s_waitcnt lgkmcnt(2)
    v_mfma_f32_32x32x16_bf16 v[8:23], v[80:83], a[32:35], v[8:23]
    ds_read_b128 v[48:51], v75 offset:8192
    v_mfma_f32_32x32x16_bf16 v[24:39], v[84:87], a[32:35], v[24:39]
    ds_read_b128 v[52:55], v75 offset:9216
    s_waitcnt lgkmcnt(2)
    v_mfma_f32_32x32x16_bf16 v[8:23], v[40:43], a[36:39], v[8:23]
    ds_read_b128 v[80:83], v75 offset:12288
    v_mfma_f32_32x32x16_bf16 v[24:39], v[44:47], a[36:39], v[24:39]
    ds_read_b128 v[84:87], v75 offset:13312
    s_add_u32 m0, s51, 106496
    s_nop 0
    buffer_load_dwordx4 v74, s[36:39], s50 offen sc1 lds
    s_add_u32 s50, s50, 8192
    s_waitcnt lgkmcnt(2)
    v_mfma_f32_32x32x16_bf16 v[8:23], v[48:51], a[40:43], v[8:23]
    ds_read_b128 v[40:43], v75 offset:16384
    v_mfma_f32_32x32x16_bf16 v[24:39], v[52:55], a[40:43], v[24:39]
    ds_read_b128 v[44:47], v75 offset:17408
    s_waitcnt lgkmcnt(2)
    v_mfma_f32_32x32x16_bf16 v[8:23], v[80:83], a[44:47], v[8:23]
    ds_read_b128 v[48:51], v75 offset:20480
    v_mfma_f32_32x32x16_bf16 v[24:39], v[84:87], a[44:47], v[24:39]
    ds_read_b128 v[52:55], v75 offset:21504
    s_add_u32 m0, s51, 114688
    s_nop 0
    buffer_load_dwordx4 v74, s[36:39], s50 offen sc1 lds
    s_add_u32 s50, s50, 8192
    s_waitcnt lgkmcnt(2)
    v_mfma_f32_32x32x16_bf16 v[8:23], v[40:43], a[48:51], v[8:23]
    ds_read_b128 v[80:83], v75 offset:24576
    v_mfma_f32_32x32x16_bf16 v[24:39], v[44:47], a[48:51], v[24:39]
    ds_read_b128 v[84:87], v75 offset:25600
    s_waitcnt lgkmcnt(2)
    v_mfma_f32_32x32x16_bf16 v[8:23], v[48:51], a[52:55], v[8:23]
    ds_read_b128 v[40:43], v75 offset:28672
    v_mfma_f32_32x32x16_bf16 v[24:39], v[52:55], a[52:55], v[24:39]
    ds_read_b128 v[44:47], v75 offset:29696
    s_add_u32 m0, s51, 122880
    s_nop 0
    buffer_load_dwordx4 v74, s[36:39], s50 offen sc1 lds
    s_add_u32 s50, s50, 8192
    s_waitcnt lgkmcnt(2)
    v_mfma_f32_32x32x16_bf16 v[8:23], v[80:83], a[56:59], v[8:23]
    v_mfma_f32_32x32x16_bf16 v[24:39], v[84:87], a[56:59], v[24:39]
    s_waitcnt lgkmcnt(0)
    s_waitcnt vmcnt(4)
    s_waitcnt vmcnt(10)
    s_barrier
    v_subrev_u32 v75, 0x18000, v75
    ds_read_b128 v[48:51], v75 offset:0
    ds_read_b128 v[52:55], v75 offset:1024
    v_mfma_f32_32x32x16_bf16 v[8:23], v[40:43], a[60:63], v[8:23]
    ds_read_b128 v[80:83], v75 offset:4096
    ds_read_b128 v[84:87], v75 offset:5120
    v_mfma_f32_32x32x16_bf16 v[24:39], v[44:47], a[60:63], v[24:39]
    s_cmp_lg_u32 s40, 0
    s_cbranch_scc1 parallel_sum__linear_kernel_hedgehog__dense_activation_squared_relu__prompt_kernel_o_58
    s_lshl_b32 s54, s43, 7
    s_lshl_b32 s55, s44, 2
    s_add_u32 s54, s54, s55
    s_add_u32 s54, s54, 6144
    v_mov_b32 v2, s54
    v_mov_b32 v3, s82
    buffer_store_dword v3, v2, s[32:35], 0 offen sc1
parallel_sum__linear_kernel_hedgehog__dense_activation_squared_relu__prompt_kernel_o_58:
    s_waitcnt lgkmcnt(2)
    v_mfma_f32_32x32x16_bf16 v[8:23], v[48:51], a[64:67], v[8:23]
    ds_read_b128 v[40:43], v75 offset:8192
    v_mfma_f32_32x32x16_bf16 v[24:39], v[52:55], a[64:67], v[24:39]
    ds_read_b128 v[44:47], v75 offset:9216
    s_waitcnt lgkmcnt(2)
    v_mfma_f32_32x32x16_bf16 v[8:23], v[80:83], a[68:71], v[8:23]
    ds_read_b128 v[48:51], v75 offset:12288
    v_mfma_f32_32x32x16_bf16 v[24:39], v[84:87], a[68:71], v[24:39]
    ds_read_b128 v[52:55], v75 offset:13312
    s_waitcnt lgkmcnt(2)
    v_mfma_f32_32x32x16_bf16 v[8:23], v[40:43], a[72:75], v[8:23]
    ds_read_b128 v[80:83], v75 offset:16384
    v_mfma_f32_32x32x16_bf16 v[24:39], v[44:47], a[72:75], v[24:39]
    ds_read_b128 v[84:87], v75 offset:17408
    s_waitcnt lgkmcnt(2)
    v_mfma_f32_32x32x16_bf16 v[8:23], v[48:51], a[76:79], v[8:23]
    ds_read_b128 v[40:43], v75 offset:20480
    v_mfma_f32_32x32x16_bf16 v[24:39], v[52:55], a[76:79], v[24:39]
    ds_read_b128 v[44:47], v75 offset:21504
    s_waitcnt lgkmcnt(2)
    v_mfma_f32_32x32x16_bf16 v[8:23], v[80:83], a[80:83], v[8:23]
    ds_read_b128 v[48:51], v75 offset:24576
    v_mfma_f32_32x32x16_bf16 v[24:39], v[84:87], a[80:83], v[24:39]
    ds_read_b128 v[52:55], v75 offset:25600
    s_waitcnt lgkmcnt(2)
    v_mfma_f32_32x32x16_bf16 v[8:23], v[40:43], a[84:87], v[8:23]
    ds_read_b128 v[80:83], v75 offset:28672
    v_mfma_f32_32x32x16_bf16 v[24:39], v[44:47], a[84:87], v[24:39]
    ds_read_b128 v[84:87], v75 offset:29696
    s_waitcnt lgkmcnt(2)
    v_mfma_f32_32x32x16_bf16 v[8:23], v[48:51], a[88:91], v[8:23]
    v_mfma_f32_32x32x16_bf16 v[24:39], v[52:55], a[88:91], v[24:39]
    s_waitcnt lgkmcnt(0)
    s_waitcnt vmcnt(6)
    s_barrier
    v_add_u32 v75, 0x8000, v75
    ds_read_b128 v[40:43], v75 offset:0
    ds_read_b128 v[44:47], v75 offset:1024
    v_mfma_f32_32x32x16_bf16 v[8:23], v[80:83], a[92:95], v[8:23]
    ds_read_b128 v[48:51], v75 offset:4096
    ds_read_b128 v[52:55], v75 offset:5120
    v_mfma_f32_32x32x16_bf16 v[24:39], v[84:87], a[92:95], v[24:39]
    s_waitcnt lgkmcnt(2)
    v_mfma_f32_32x32x16_bf16 v[8:23], v[40:43], a[96:99], v[8:23]
    ds_read_b128 v[80:83], v75 offset:8192
    v_mfma_f32_32x32x16_bf16 v[24:39], v[44:47], a[96:99], v[24:39]
    ds_read_b128 v[84:87], v75 offset:9216
    s_waitcnt lgkmcnt(2)
    v_mfma_f32_32x32x16_bf16 v[8:23], v[48:51], a[100:103], v[8:23]
    ds_read_b128 v[40:43], v75 offset:12288
    v_mfma_f32_32x32x16_bf16 v[24:39], v[52:55], a[100:103], v[24:39]
    ds_read_b128 v[44:47], v75 offset:13312
    s_waitcnt lgkmcnt(2)
    v_mfma_f32_32x32x16_bf16 v[8:23], v[80:83], a[104:107], v[8:23]
    ds_read_b128 v[48:51], v75 offset:16384
    v_mfma_f32_32x32x16_bf16 v[24:39], v[84:87], a[104:107], v[24:39]
    ds_read_b128 v[52:55], v75 offset:17408
    s_waitcnt lgkmcnt(2)
    v_mfma_f32_32x32x16_bf16 v[8:23], v[40:43], a[108:111], v[8:23]
    ds_read_b128 v[80:83], v75 offset:20480
    v_mfma_f32_32x32x16_bf16 v[24:39], v[44:47], a[108:111], v[24:39]
    ds_read_b128 v[84:87], v75 offset:21504
    s_waitcnt lgkmcnt(2)
    v_mfma_f32_32x32x16_bf16 v[8:23], v[48:51], a[112:115], v[8:23]
    ds_read_b128 v[40:43], v75 offset:24576
    v_mfma_f32_32x32x16_bf16 v[24:39], v[52:55], a[112:115], v[24:39]
    ds_read_b128 v[44:47], v75 offset:25600
    s_waitcnt lgkmcnt(2)
    v_mfma_f32_32x32x16_bf16 v[8:23], v[80:83], a[116:119], v[8:23]
    ds_read_b128 v[48:51], v75 offset:28672
    v_mfma_f32_32x32x16_bf16 v[24:39], v[84:87], a[116:119], v[24:39]
    ds_read_b128 v[52:55], v75 offset:29696
    s_waitcnt lgkmcnt(2)
    v_mfma_f32_32x32x16_bf16 v[8:23], v[40:43], a[120:123], v[8:23]
    v_mfma_f32_32x32x16_bf16 v[24:39], v[44:47], a[120:123], v[24:39]
    s_waitcnt lgkmcnt(0)
    s_waitcnt vmcnt(0)
    s_barrier
    v_add_u32 v75, 0x8000, v75
    ds_read_b128 v[80:83], v75 offset:0
    ds_read_b128 v[84:87], v75 offset:1024
    v_mfma_f32_32x32x16_bf16 v[8:23], v[48:51], a[124:127], v[8:23]
    ds_read_b128 v[40:43], v75 offset:4096
    ds_read_b128 v[44:47], v75 offset:5120
    v_mfma_f32_32x32x16_bf16 v[24:39], v[52:55], a[124:127], v[24:39]
    s_waitcnt lgkmcnt(2)
    v_mfma_f32_32x32x16_bf16 v[8:23], v[80:83], a[128:131], v[8:23]
    ds_read_b128 v[48:51], v75 offset:8192
    v_mfma_f32_32x32x16_bf16 v[24:39], v[84:87], a[128:131], v[24:39]
    ds_read_b128 v[52:55], v75 offset:9216
    s_cmp_lg_u32 s40, 0
    s_cbranch_scc1 parallel_sum__linear_kernel_hedgehog__dense_activation_squared_relu__prompt_kernel_o_59
    v_and_b32 v89, 15, v1
    v_lshlrev_b32 v89, 2, v89
    s_mov_b32 s54, 4096
    buffer_load_dwordx4 v[64:67], v74, s[32:35], s54 offen sc1
    s_lshl_b32 s54, s43, 7
    s_add_u32 s54, s54, 6144
    buffer_load_dword v68, v89, s[32:35], s54 offen sc1
parallel_sum__linear_kernel_hedgehog__dense_activation_squared_relu__prompt_kernel_o_59:
    s_waitcnt lgkmcnt(2)
    v_mfma_f32_32x32x16_bf16 v[8:23], v[40:43], a[132:135], v[8:23]
    ds_read_b128 v[80:83], v75 offset:12288
    v_mfma_f32_32x32x16_bf16 v[24:39], v[44:47], a[132:135], v[24:39]
    ds_read_b128 v[84:87], v75 offset:13312
    s_waitcnt lgkmcnt(2)
    v_mfma_f32_32x32x16_bf16 v[8:23], v[48:51], a[136:139], v[8:23]
    ds_read_b128 v[40:43], v75 offset:16384
    v_mfma_f32_32x32x16_bf16 v[24:39], v[52:55], a[136:139], v[24:39]
    ds_read_b128 v[44:47], v75 offset:17408
    s_waitcnt lgkmcnt(2)
    v_mfma_f32_32x32x16_bf16 v[8:23], v[80:83], a[140:143], v[8:23]
    ds_read_b128 v[48:51], v75 offset:20480
    v_mfma_f32_32x32x16_bf16 v[24:39], v[84:87], a[140:143], v[24:39]
    ds_read_b128 v[52:55], v75 offset:21504
    s_waitcnt lgkmcnt(2)
    v_mfma_f32_32x32x16_bf16 v[8:23], v[40:43], a[144:147], v[8:23]
    ds_read_b128 v[80:83], v75 offset:24576
    v_mfma_f32_32x32x16_bf16 v[24:39], v[44:47], a[144:147], v[24:39]
    ds_read_b128 v[84:87], v75 offset:25600
    s_waitcnt lgkmcnt(2)
    v_mfma_f32_32x32x16_bf16 v[8:23], v[48:51], a[148:151], v[8:23]
    ds_read_b128 v[40:43], v75 offset:28672
    v_mfma_f32_32x32x16_bf16 v[24:39], v[52:55], a[148:151], v[24:39]
    ds_read_b128 v[44:47], v75 offset:29696
    s_waitcnt lgkmcnt(2)
    v_mfma_f32_32x32x16_bf16 v[8:23], v[80:83], a[152:155], v[8:23]
    v_mfma_f32_32x32x16_bf16 v[24:39], v[84:87], a[152:155], v[24:39]
    s_waitcnt lgkmcnt(0)
    v_mfma_f32_32x32x16_bf16 v[8:23], v[40:43], a[156:159], v[8:23]
    v_mfma_f32_32x32x16_bf16 v[24:39], v[44:47], a[156:159], v[24:39]
    v_mfma_f32_32x32x16_bf16 v[8:23], v[56:59], v[92:95], v[8:23]
    v_mfma_f32_32x32x16_bf16 v[24:39], v[60:63], v[92:95], v[24:39]
    s_cmp_lg_u32 s40, 0
    s_cbranch_scc1 parallel_sum__linear_kernel_hedgehog__dense_activation_squared_relu__prompt_kernel_o_60
    s_waitcnt vmcnt(0)
    s_mov_b32 s52, 0x40000
parallel_sum__linear_kernel_hedgehog__dense_activation_squared_relu__prompt_kernel_sp_61:
    v_xor_b32 v2, s82, v64
    v_xor_b32 v3, s82, v65
    v_xor_b32 v4, s82, v66
    v_xor_b32 v5, s82, v67
    v_or3_b32 v2, v2, v3, v4
    v_xor_b32 v3, s82, v68
    v_or3_b32 v2, v2, v5, v3
    v_cmp_ne_u32 vcc, 0, v2
    s_nop 4
    s_cbranch_vccz parallel_sum__linear_kernel_hedgehog__dense_activation_squared_relu__prompt_kernel_sd_62
    s_sub_u32 s52, s52, 1
    s_cmp_eq_u32 s52, 0
    s_cbranch_scc1 parallel_sum__linear_kernel_hedgehog__dense_activation_squared_relu__prompt_kernel_sd_62
    s_sleep 8
    s_mov_b32 s54, 4096
    buffer_load_dwordx4 v[64:67], v74, s[32:35], s54 offen sc1
    s_lshl_b32 s54, s43, 7
    s_add_u32 s54, s54, 6144
    buffer_load_dword v68, v89, s[32:35], s54 offen sc1
    s_waitcnt vmcnt(0)
    s_branch parallel_sum__linear_kernel_hedgehog__dense_activation_squared_relu__prompt_kernel_sp_61
parallel_sum__linear_kernel_hedgehog__dense_activation_squared_relu__prompt_kernel_sd_62:
    s_cmp_lg_u32 s2, 0
    s_cbranch_scc1 parallel_sum__linear_kernel_hedgehog__dense_activation_squared_relu__prompt_kernel_o_63
    v_mov_b32 v2, 0
    buffer_store_dword v2, v2, s[24:27], 0 offen sc1
parallel_sum__linear_kernel_hedgehog__dense_activation_squared_relu__prompt_kernel_o_63:
parallel_sum__linear_kernel_hedgehog__dense_activation_squared_relu__prompt_kernel_o_60:
    s_barrier
    s_add_u32 s28, s66, 10485760
    s_addc_u32 s29, s67, 0
    s_mov_b32 s30, 3031040
    s_mov_b32 s31, 0x20000
    s_and_b32 s46, s44, 7
    s_lshr_b32 s45, s44, 3
    s_lshl_b32 s54, s43, 1
    s_add_u32 s45, s45, s54
    s_mul_i32 s85, s46, 74
    s_add_u32 s85, s85, s41
    s_mul_i32 s85, s85, 5120
    s_mul_i32 s86, s45, 74
    s_add_u32 s86, s86, s41
    s_lshl_b32 s86, s86, 12
    v_add_u32 v72, 0x1000, v74
    v_mov_b32 v68, v76
    v_mov_b32 v69, v76
    v_and_b32 v89, 31, v1
    s_lshl_b32 s54, s41, 5
    v_add_u32 v89, s54, v89
    v_mul_u32_u24 v90, 96, v89
    v_mul_u32_u24 v2, 24, v6
    v_add_u32 v90, v90, v2
    s_mul_i32 s54, s42, 48
    s_add_u32 s54, s54, 49152
    v_add_u32 v90, s54, v90
    v_mul_u32_u24 v91, 160, v89
    v_mul_u32_u24 v2, 20480, v6
    v_add_u32 v91, v91, v2
    s_mul_i32 s54, s42, 80
    s_add_u32 s54, s54, 8192
    v_add_u32 v91, s54, v91
    v_bfe_u32 v2, v1, 2, 2
    v_bfe_u32 v3, v1, 4, 1
    v_and_b32 v4, 3, v1
    v_lshl_add_u32 v3, v3, 2, v4
    v_lshrrev_b32 v59, 1, v3
    v_and_b32 v3, 1, v3
    v_mul_u32_u24 v2, 40, v2
    s_mul_i32 s54, s42, 800
    s_add_u32 s54, s54, 5120
    v_add_u32 v2, s54, v2
    v_lshl_add_u32 v56, v59, 3, v2
    v_add_u32 v57, 32, v2
    v_mov_b32 v58, 7168
    v_cmp_eq_u32 vcc, v3, v6
    s_nop 1
    v_cndmask_b32 v56, v58, v56, vcc
    v_cndmask_b32 v57, v58, v57, vcc
    v_cmp_eq_u32 vcc, 0, v59
    s_nop 1
    v_cndmask_b32 v57, v58, v57, vcc
    ds_read_b64_tr_b16 v[60:61], v56 offset:0
    ds_read_b64_tr_b16 v[62:63], v56 offset:160
    ds_read_b64_tr_b16 v[64:65], v56 offset:320
    ds_read_b64_tr_b16 v[66:67], v56 offset:480
    ds_read_b64_tr_b16 v[52:53], v56 offset:640
    ds_read_b64_tr_b16 v[80:81], v57 offset:0
    ds_read_b64_tr_b16 v[82:83], v57 offset:160
    ds_read_b64_tr_b16 v[84:85], v57 offset:320
    ds_read_b64_tr_b16 v[86:87], v57 offset:480
    ds_read_b64_tr_b16 v[92:93], v57 offset:640
    v_mov_b32 v54, 0
    v_mov_b32 v55, 0
    v_mov_b32 v94, 0
    v_mov_b32 v95, 0
    v_cvt_pk_bf16_f32 v40, v8, v9
    v_cvt_pk_bf16_f32 v41, v10, v11
    v_cvt_pk_bf16_f32 v42, v12, v13
    v_cvt_pk_bf16_f32 v43, v14, v15
    v_cvt_pk_bf16_f32 v44, v16, v17
    v_cvt_pk_bf16_f32 v45, v18, v19
    v_cvt_pk_bf16_f32 v46, v20, v21
    v_cvt_pk_bf16_f32 v47, v22, v23
    v_cvt_pk_bf16_f32 v48, v24, v25
    v_cvt_pk_bf16_f32 v49, v26, v27
    v_mov_b32 v50, 0
    v_mov_b32 v51, 0
    v_pk_mul_f32 v[28:29], v[28:29], v[68:69]
    v_pk_mul_f32 v[30:31], v[30:31], v[68:69]
    v_pk_mul_f32 v[32:33], v[32:33], v[68:69]
    v_pk_mul_f32 v[34:35], v[34:35], v[68:69]
    v_pk_mul_f32 v[36:37], v[36:37], v[68:69]
    v_pk_mul_f32 v[38:39], v[38:39], v[68:69]
    v_cvt_pk_bf16_f32 v28, v28, v29
    v_cvt_pk_bf16_f32 v29, v30, v31
    v_cvt_pk_bf16_f32 v30, v32, v33
    v_cvt_pk_bf16_f32 v31, v34, v35
    v_cvt_pk_bf16_f32 v32, v36, v37
    v_cvt_pk_bf16_f32 v33, v38, v39
    v_mov_b32 v2, 0x3f80
    v_mov_b32 v3, 0
    v_cndmask_b32 v32, v32, v2, s[80:81]
    v_cndmask_b32 v33, v33, v3, s[80:81]
    ds_write_b64 v90, v[28:29] offset:0
    ds_write_b64 v90, v[30:31] offset:8
    ds_write_b64 v90, v[32:33] offset:16
    s_waitcnt lgkmcnt(11)
    v_mfma_f32_32x32x16_bf16 v[8:23], v[60:63], v[40:43], 0
    s_waitcnt lgkmcnt(9)
    v_mfma_f32_32x32x16_bf16 v[8:23], v[64:67], v[44:47], v[8:23]
    s_waitcnt lgkmcnt(8)
    v_mfma_f32_32x32x16_bf16 v[8:23], v[52:55], v[48:51], v[8:23]
    s_waitcnt lgkmcnt(0)
    v_mfma_f32_32x32x16_bf16 v[24:39], v[80:83], v[40:43], 0
    v_mfma_f32_32x32x16_bf16 v[24:39], v[84:87], v[44:47], v[24:39]
    v_mfma_f32_32x32x16_bf16 v[24:39], v[92:95], v[48:51], v[24:39]
    s_nop 7
    v_max3_f32 v2, v8, v9, v10
    v_min3_f32 v3, v8, v9, v10
    v_max3_f32 v2, v2, v11, v12
    v_min3_f32 v3, v3, v11, v12
    v_max3_f32 v2, v2, v13, v14
    v_min3_f32 v3, v3, v13, v14
    v_max3_f32 v2, v2, v15, v16
    v_min3_f32 v3, v3, v15, v16
    v_max3_f32 v2, v2, v17, v18
    v_min3_f32 v3, v3, v17, v18
    v_max3_f32 v2, v2, v19, v20
    v_min3_f32 v3, v3, v19, v20
    v_max3_f32 v2, v2, v21, v22
    v_min3_f32 v3, v3, v21, v22
    v_max_f32 v2, v2, v23
    v_min_f32 v3, v3, v23
    v_max3_f32 v2, v2, v24, v25
    v_min3_f32 v3, v3, v24, v25
    v_max3_f32 v2, v2, v26, v27
    v_min3_f32 v3, v3, v26, v27
    v_mov_b32 v60, v77
    v_mov_b32 v61, v77
    v_mul_f32 v62, v2, v77
    v_mul_f32 v64, v3, v77
    v_mov_b32 v63, v62
    v_mov_b32 v65, v64
    v_pk_fma_f32 v[40:41], v[8:9], v[60:61], v[64:65] neg_lo:[1,0,0] neg_hi:[1,0,0]
    v_pk_fma_f32 v[8:9], v[8:9], v[60:61], v[62:63] neg_lo:[0,0,1] neg_hi:[0,0,1]
    v_pk_fma_f32 v[42:43], v[10:11], v[60:61], v[64:65] neg_lo:[1,0,0] neg_hi:[1,0,0]
    v_pk_fma_f32 v[10:11], v[10:11], v[60:61], v[62:63] neg_lo:[0,0,1] neg_hi:[0,0,1]
    v_pk_fma_f32 v[44:45], v[12:13], v[60:61], v[64:65] neg_lo:[1,0,0] neg_hi:[1,0,0]
    v_pk_fma_f32 v[12:13], v[12:13], v[60:61], v[62:63] neg_lo:[0,0,1] neg_hi:[0,0,1]
    v_pk_fma_f32 v[46:47], v[14:15], v[60:61], v[64:65] neg_lo:[1,0,0] neg_hi:[1,0,0]
    v_pk_fma_f32 v[14:15], v[14:15], v[60:61], v[62:63] neg_lo:[0,0,1] neg_hi:[0,0,1]
    v_pk_fma_f32 v[48:49], v[16:17], v[60:61], v[64:65] neg_lo:[1,0,0] neg_hi:[1,0,0]
    v_pk_fma_f32 v[16:17], v[16:17], v[60:61], v[62:63] neg_lo:[0,0,1] neg_hi:[0,0,1]
    v_pk_fma_f32 v[50:51], v[18:19], v[60:61], v[64:65] neg_lo:[1,0,0] neg_hi:[1,0,0]
    v_pk_fma_f32 v[18:19], v[18:19], v[60:61], v[62:63] neg_lo:[0,0,1] neg_hi:[0,0,1]
    v_pk_fma_f32 v[52:53], v[20:21], v[60:61], v[64:65] neg_lo:[1,0,0] neg_hi:[1,0,0]
    v_pk_fma_f32 v[20:21], v[20:21], v[60:61], v[62:63] neg_lo:[0,0,1] neg_hi:[0,0,1]
    v_pk_fma_f32 v[54:55], v[22:23], v[60:61], v[64:65] neg_lo:[1,0,0] neg_hi:[1,0,0]
    v_pk_fma_f32 v[22:23], v[22:23], v[60:61], v[62:63] neg_lo:[0,0,1] neg_hi:[0,0,1]
    v_pk_fma_f32 v[56:57], v[24:25], v[60:61], v[64:65] neg_lo:[1,0,0] neg_hi:[1,0,0]
    v_pk_fma_f32 v[24:25], v[24:25], v[60:61], v[62:63] neg_lo:[0,0,1] neg_hi:[0,0,1]
    v_pk_fma_f32 v[58:59], v[26:27], v[60:61], v[64:65] neg_lo:[1,0,0] neg_hi:[1,0,0]
    v_pk_fma_f32 v[26:27], v[26:27], v[60:61], v[62:63] neg_lo:[0,0,1] neg_hi:[0,0,1]
    v_exp_f32 v40, v40
    v_exp_f32 v8, v8
    v_exp_f32 v41, v41
    v_exp_f32 v9, v9
    v_exp_f32 v42, v42
    v_exp_f32 v10, v10
    v_exp_f32 v43, v43
    v_exp_f32 v11, v11
    v_exp_f32 v44, v44
    v_exp_f32 v12, v12
    v_exp_f32 v45, v45
    v_exp_f32 v13, v13
    v_exp_f32 v46, v46
    v_exp_f32 v14, v14
    v_exp_f32 v47, v47
    v_exp_f32 v15, v15
    v_exp_f32 v48, v48
    v_exp_f32 v16, v16
    v_exp_f32 v49, v49
    v_exp_f32 v17, v17
    v_exp_f32 v50, v50
    v_exp_f32 v18, v18
    v_exp_f32 v51, v51
    v_exp_f32 v19, v19
    v_exp_f32 v52, v52
    v_exp_f32 v20, v20
    v_exp_f32 v53, v53
    v_exp_f32 v21, v21
    v_exp_f32 v54, v54
    v_exp_f32 v22, v22
    v_exp_f32 v55, v55
    v_exp_f32 v23, v23
    v_exp_f32 v56, v56
    v_exp_f32 v24, v24
    v_exp_f32 v57, v57
    v_exp_f32 v25, v25
    v_exp_f32 v58, v58
    v_exp_f32 v26, v26
    v_exp_f32 v59, v59
    v_exp_f32 v27, v27
    v_pk_add_f32 v[66:67], v[8:9], v[10:11]
    v_pk_add_f32 v[68:69], v[40:41], v[42:43]
    v_pk_add_f32 v[66:67], v[66:67], v[12:13]
    v_pk_add_f32 v[68:69], v[68:69], v[44:45]
    v_pk_add_f32 v[66:67], v[66:67], v[14:15]
    v_pk_add_f32 v[68:69], v[68:69], v[46:47]
    v_pk_add_f32 v[66:67], v[66:67], v[16:17]
    v_pk_add_f32 v[68:69], v[68:69], v[48:49]
    v_pk_add_f32 v[66:67], v[66:67], v[18:19]
    v_pk_add_f32 v[68:69], v[68:69], v[50:51]
    v_pk_add_f32 v[66:67], v[66:67], v[20:21]
    v_pk_add_f32 v[68:69], v[68:69], v[52:53]
    v_pk_add_f32 v[66:67], v[66:67], v[22:23]
    v_pk_add_f32 v[68:69], v[68:69], v[54:55]
    v_pk_add_f32 v[66:67], v[66:67], v[24:25]
    v_pk_add_f32 v[68:69], v[68:69], v[56:57]
    v_pk_add_f32 v[66:67], v[66:67], v[26:27]
    v_pk_add_f32 v[68:69], v[68:69], v[58:59]
    v_add_f32 v66, v66, v67
    v_add_f32 v68, v68, v69
    v_rcp_f32 v66, v66
    v_rcp_f32 v68, v68
    v_mov_b32 v67, v66
    v_mov_b32 v69, v68
    v_pk_mul_f32 v[8:9], v[8:9], v[66:67]
    v_pk_mul_f32 v[40:41], v[40:41], v[68:69]
    v_pk_mul_f32 v[10:11], v[10:11], v[66:67]
    v_pk_mul_f32 v[42:43], v[42:43], v[68:69]
    v_pk_mul_f32 v[12:13], v[12:13], v[66:67]
    v_pk_mul_f32 v[44:45], v[44:45], v[68:69]
    v_pk_mul_f32 v[14:15], v[14:15], v[66:67]
    v_pk_mul_f32 v[46:47], v[46:47], v[68:69]
    v_pk_mul_f32 v[16:17], v[16:17], v[66:67]
    v_pk_mul_f32 v[48:49], v[48:49], v[68:69]
    v_pk_mul_f32 v[18:19], v[18:19], v[66:67]
    v_pk_mul_f32 v[50:51], v[50:51], v[68:69]
    v_pk_mul_f32 v[20:21], v[20:21], v[66:67]
    v_pk_mul_f32 v[52:53], v[52:53], v[68:69]
    v_pk_mul_f32 v[22:23], v[22:23], v[66:67]
    v_pk_mul_f32 v[54:55], v[54:55], v[68:69]
    v_pk_mul_f32 v[24:25], v[24:25], v[66:67]
    v_pk_mul_f32 v[56:57], v[56:57], v[68:69]
    v_pk_mul_f32 v[26:27], v[26:27], v[66:67]
    v_pk_mul_f32 v[58:59], v[58:59], v[68:69]
    v_cvt_pk_bf16_f32 v8, v8, v9
    v_cvt_pk_bf16_f32 v9, v10, v11
    v_cvt_pk_bf16_f32 v10, v12, v13
    v_cvt_pk_bf16_f32 v11, v14, v15
    v_cvt_pk_bf16_f32 v12, v16, v17
    v_cvt_pk_bf16_f32 v13, v18, v19
    v_cvt_pk_bf16_f32 v14, v20, v21
    v_cvt_pk_bf16_f32 v15, v22, v23
    v_cvt_pk_bf16_f32 v16, v24, v25
    v_cvt_pk_bf16_f32 v17, v26, v27
    v_cvt_pk_bf16_f32 v18, v40, v41
    v_cvt_pk_bf16_f32 v19, v42, v43
    v_cvt_pk_bf16_f32 v20, v44, v45
    v_cvt_pk_bf16_f32 v21, v46, v47
    v_cvt_pk_bf16_f32 v22, v48, v49
    v_cvt_pk_bf16_f32 v23, v50, v51
    v_cvt_pk_bf16_f32 v24, v52, v53
    v_cvt_pk_bf16_f32 v25, v54, v55
    v_cvt_pk_bf16_f32 v26, v56, v57
    v_cvt_pk_bf16_f32 v27, v58, v59
    ds_write_b128 v91, v[8:11] offset:0
    ds_write_b128 v91, v[12:15] offset:16
    ds_write_b128 v91, v[16:19] offset:32
    ds_write_b128 v91, v[20:23] offset:48
    ds_write_b128 v91, v[24:27] offset:64
    s_waitcnt lgkmcnt(0)
    s_barrier
    s_cmp_lt_u32 s40, 4
    s_cbranch_scc1 parallel_sum__linear_kernel_hedgehog__dense_activation_squared_relu__prompt_kernel_chain
    s_add_u32 s55, s86, 0
    buffer_load_dwordx4 a[100:103], v74, s[16:19], s55 offen offset:0 sc1
    buffer_load_dwordx4 a[104:107], v74, s[16:19], s55 offen offset:1024 sc1
    buffer_load_dwordx4 a[108:111], v74, s[16:19], s55 offen offset:2048 sc1
    buffer_load_dwordx4 a[112:115], v74, s[16:19], s55 offen offset:3072 sc1
    s_add_u32 s54, s85, 0
    buffer_load_dwordx4 a[80:83], v74, s[28:31], s54 offen offset:0 sc1
    buffer_load_dwordx4 a[84:87], v74, s[28:31], s54 offen offset:1024 sc1
    buffer_load_dwordx4 a[88:91], v74, s[28:31], s54 offen offset:2048 sc1
    buffer_load_dwordx4 a[92:95], v74, s[28:31], s54 offen offset:3072 sc1
    buffer_load_dwordx4 a[96:99], v72, s[28:31], s54 offen sc1
    s_add_u32 s55, s86, 16384
    buffer_load_dwordx4 a[136:139], v74, s[16:19], s55 offen offset:0 sc1
    buffer_load_dwordx4 a[140:143], v74, s[16:19], s55 offen offset:1024 sc1
    buffer_load_dwordx4 a[144:147], v74, s[16:19], s55 offen offset:2048 sc1
    buffer_load_dwordx4 a[148:151], v74, s[16:19], s55 offen offset:3072 sc1
    s_add_u32 s54, s85, 20480
    buffer_load_dwordx4 a[116:119], v74, s[28:31], s54 offen offset:0 sc1
    buffer_load_dwordx4 a[120:123], v74, s[28:31], s54 offen offset:1024 sc1
    buffer_load_dwordx4 a[124:127], v74, s[28:31], s54 offen offset:2048 sc1
    buffer_load_dwordx4 a[128:131], v74, s[28:31], s54 offen offset:3072 sc1
    buffer_load_dwordx4 a[132:135], v72, s[28:31], s54 offen sc1
    s_add_u32 s55, s86, 32768
    buffer_load_dwordx4 v[28:31], v74, s[16:19], s55 offen offset:0 sc1
    buffer_load_dwordx4 v[32:35], v74, s[16:19], s55 offen offset:1024 sc1
    buffer_load_dwordx4 v[36:39], v74, s[16:19], s55 offen offset:2048 sc1
    buffer_load_dwordx4 v[40:43], v74, s[16:19], s55 offen offset:3072 sc1
    s_add_u32 s54, s85, 40960
    buffer_load_dwordx4 v[8:11], v74, s[28:31], s54 offen offset:0 sc1
    buffer_load_dwordx4 v[12:15], v74, s[28:31], s54 offen offset:1024 sc1
    buffer_load_dwordx4 v[16:19], v74, s[28:31], s54 offen offset:2048 sc1
    buffer_load_dwordx4 v[20:23], v74, s[28:31], s54 offen offset:3072 sc1
    buffer_load_dwordx4 v[24:27], v72, s[28:31], s54 offen sc1
    s_add_u32 s55, s86, 49152
    buffer_load_dwordx4 v[64:67], v74, s[16:19], s55 offen offset:0 sc1
    buffer_load_dwordx4 v[68:71], v74, s[16:19], s55 offen offset:1024 sc1
    buffer_load_dwordx4 v[80:83], v74, s[16:19], s55 offen offset:2048 sc1
    buffer_load_dwordx4 v[84:87], v74, s[16:19], s55 offen offset:3072 sc1
    s_add_u32 s54, s85, 61440
    buffer_load_dwordx4 v[44:47], v74, s[28:31], s54 offen offset:0 sc1
    buffer_load_dwordx4 v[48:51], v74, s[28:31], s54 offen offset:1024 sc1
    buffer_load_dwordx4 v[52:55], v74, s[28:31], s54 offen offset:2048 sc1
    buffer_load_dwordx4 v[56:59], v74, s[28:31], s54 offen offset:3072 sc1
    buffer_load_dwordx4 v[60:63], v72, s[28:31], s54 offen sc1
    s_waitcnt vmcnt(27)
    v_mfma_f32_16x16x32_bf16 a[0:3], a[80:83], a[100:103], 0
    v_mfma_f32_16x16x32_bf16 a[4:7], a[80:83], a[104:107], 0
    v_mfma_f32_16x16x32_bf16 a[8:11], a[80:83], a[108:111], 0
    v_mfma_f32_16x16x32_bf16 a[12:15], a[80:83], a[112:115], 0
    v_mfma_f32_16x16x32_bf16 a[16:19], a[84:87], a[100:103], 0
    v_mfma_f32_16x16x32_bf16 a[20:23], a[84:87], a[104:107], 0
    v_mfma_f32_16x16x32_bf16 a[24:27], a[84:87], a[108:111], 0
    v_mfma_f32_16x16x32_bf16 a[28:31], a[84:87], a[112:115], 0
    v_mfma_f32_16x16x32_bf16 a[32:35], a[88:91], a[100:103], 0
    v_mfma_f32_16x16x32_bf16 a[36:39], a[88:91], a[104:107], 0
    v_mfma_f32_16x16x32_bf16 a[40:43], a[88:91], a[108:111], 0
    v_mfma_f32_16x16x32_bf16 a[44:47], a[88:91], a[112:115], 0
    v_mfma_f32_16x16x32_bf16 a[48:51], a[92:95], a[100:103], 0
    v_mfma_f32_16x16x32_bf16 a[52:55], a[92:95], a[104:107], 0
    v_mfma_f32_16x16x32_bf16 a[56:59], a[92:95], a[108:111], 0
    v_mfma_f32_16x16x32_bf16 a[60:63], a[92:95], a[112:115], 0
    v_mfma_f32_16x16x32_bf16 a[64:67], a[96:99], a[100:103], 0
    v_mfma_f32_16x16x32_bf16 a[68:71], a[96:99], a[104:107], 0
    v_mfma_f32_16x16x32_bf16 a[72:75], a[96:99], a[108:111], 0
    v_mfma_f32_16x16x32_bf16 a[76:79], a[96:99], a[112:115], 0
    s_add_u32 s55, s86, 65536
    buffer_load_dwordx4 a[100:103], v74, s[16:19], s55 offen offset:0 sc1
    buffer_load_dwordx4 a[104:107], v74, s[16:19], s55 offen offset:1024 sc1
    buffer_load_dwordx4 a[108:111], v74, s[16:19], s55 offen offset:2048 sc1
    buffer_load_dwordx4 a[112:115], v74, s[16:19], s55 offen offset:3072 sc1
    s_add_u32 s54, s85, 81920
    buffer_load_dwordx4 a[80:83], v74, s[28:31], s54 offen offset:0 sc1
    buffer_load_dwordx4 a[84:87], v74, s[28:31], s54 offen offset:1024 sc1
    buffer_load_dwordx4 a[88:91], v74, s[28:31], s54 offen offset:2048 sc1
    buffer_load_dwordx4 a[92:95], v74, s[28:31], s54 offen offset:3072 sc1
    buffer_load_dwordx4 a[96:99], v72, s[28:31], s54 offen sc1
    s_waitcnt vmcnt(27)
    v_mfma_f32_16x16x32_bf16 a[0:3], a[116:119], a[136:139], a[0:3]
    v_mfma_f32_16x16x32_bf16 a[4:7], a[116:119], a[140:143], a[4:7]
    v_mfma_f32_16x16x32_bf16 a[8:11], a[116:119], a[144:147], a[8:11]
    v_mfma_f32_16x16x32_bf16 a[12:15], a[116:119], a[148:151], a[12:15]
    v_mfma_f32_16x16x32_bf16 a[16:19], a[120:123], a[136:139], a[16:19]
    v_mfma_f32_16x16x32_bf16 a[20:23], a[120:123], a[140:143], a[20:23]
    v_mfma_f32_16x16x32_bf16 a[24:27], a[120:123], a[144:147], a[24:27]
    v_mfma_f32_16x16x32_bf16 a[28:31], a[120:123], a[148:151], a[28:31]
    v_mfma_f32_16x16x32_bf16 a[32:35], a[124:127], a[136:139], a[32:35]
    v_mfma_f32_16x16x32_bf16 a[36:39], a[124:127], a[140:143], a[36:39]
    v_mfma_f32_16x16x32_bf16 a[40:43], a[124:127], a[144:147], a[40:43]
    v_mfma_f32_16x16x32_bf16 a[44:47], a[124:127], a[148:151], a[44:47]
    v_mfma_f32_16x16x32_bf16 a[48:51], a[128:131], a[136:139], a[48:51]
    v_mfma_f32_16x16x32_bf16 a[52:55], a[128:131], a[140:143], a[52:55]
    v_mfma_f32_16x16x32_bf16 a[56:59], a[128:131], a[144:147], a[56:59]
    v_mfma_f32_16x16x32_bf16 a[60:63], a[128:131], a[148:151], a[60:63]
    v_mfma_f32_16x16x32_bf16 a[64:67], a[132:135], a[136:139], a[64:67]
    v_mfma_f32_16x16x32_bf16 a[68:71], a[132:135], a[140:143], a[68:71]
    v_mfma_f32_16x16x32_bf16 a[72:75], a[132:135], a[144:147], a[72:75]
    v_mfma_f32_16x16x32_bf16 a[76:79], a[132:135], a[148:151], a[76:79]
    s_add_u32 s55, s86, 81920
    buffer_load_dwordx4 a[136:139], v74, s[16:19], s55 offen offset:0 sc1
    buffer_load_dwordx4 a[140:143], v74, s[16:19], s55 offen offset:1024 sc1
    buffer_load_dwordx4 a[144:147], v74, s[16:19], s55 offen offset:2048 sc1
    buffer_load_dwordx4 a[148:151], v74, s[16:19], s55 offen offset:3072 sc1
    s_add_u32 s54, s85, 102400
    buffer_load_dwordx4 a[116:119], v74, s[28:31], s54 offen offset:0 sc1
    buffer_load_dwordx4 a[120:123], v74, s[28:31], s54 offen offset:1024 sc1
    buffer_load_dwordx4 a[124:127], v74, s[28:31], s54 offen offset:2048 sc1
    buffer_load_dwordx4 a[128:131], v74, s[28:31], s54 offen offset:3072 sc1
    buffer_load_dwordx4 a[132:135], v72, s[28:31], s54 offen sc1
    s_waitcnt vmcnt(27)
    v_mfma_f32_16x16x32_bf16 a[0:3], v[8:11], v[28:31], a[0:3]
    v_mfma_f32_16x16x32_bf16 a[4:7], v[8:11], v[32:35], a[4:7]
    v_mfma_f32_16x16x32_bf16 a[8:11], v[8:11], v[36:39], a[8:11]
    v_mfma_f32_16x16x32_bf16 a[12:15], v[8:11], v[40:43], a[12:15]
    v_mfma_f32_16x16x32_bf16 a[16:19], v[12:15], v[28:31], a[16:19]
    v_mfma_f32_16x16x32_bf16 a[20:23], v[12:15], v[32:35], a[20:23]
    v_mfma_f32_16x16x32_bf16 a[24:27], v[12:15], v[36:39], a[24:27]
    v_mfma_f32_16x16x32_bf16 a[28:31], v[12:15], v[40:43], a[28:31]
    v_mfma_f32_16x16x32_bf16 a[32:35], v[16:19], v[28:31], a[32:35]
    v_mfma_f32_16x16x32_bf16 a[36:39], v[16:19], v[32:35], a[36:39]
    v_mfma_f32_16x16x32_bf16 a[40:43], v[16:19], v[36:39], a[40:43]
    v_mfma_f32_16x16x32_bf16 a[44:47], v[16:19], v[40:43], a[44:47]
    v_mfma_f32_16x16x32_bf16 a[48:51], v[20:23], v[28:31], a[48:51]
    v_mfma_f32_16x16x32_bf16 a[52:55], v[20:23], v[32:35], a[52:55]
    v_mfma_f32_16x16x32_bf16 a[56:59], v[20:23], v[36:39], a[56:59]
    v_mfma_f32_16x16x32_bf16 a[60:63], v[20:23], v[40:43], a[60:63]
    v_mfma_f32_16x16x32_bf16 a[64:67], v[24:27], v[28:31], a[64:67]
    v_mfma_f32_16x16x32_bf16 a[68:71], v[24:27], v[32:35], a[68:71]
    v_mfma_f32_16x16x32_bf16 a[72:75], v[24:27], v[36:39], a[72:75]
    v_mfma_f32_16x16x32_bf16 a[76:79], v[24:27], v[40:43], a[76:79]
    s_add_u32 s55, s86, 98304
    buffer_load_dwordx4 v[28:31], v74, s[16:19], s55 offen offset:0 sc1
    buffer_load_dwordx4 v[32:35], v74, s[16:19], s55 offen offset:1024 sc1
    buffer_load_dwordx4 v[36:39], v74, s[16:19], s55 offen offset:2048 sc1
    buffer_load_dwordx4 v[40:43], v74, s[16:19], s55 offen offset:3072 sc1
    s_add_u32 s54, s85, 122880
    buffer_load_dwordx4 v[8:11], v74, s[28:31], s54 offen offset:0 sc1
    buffer_load_dwordx4 v[12:15], v74, s[28:31], s54 offen offset:1024 sc1
    buffer_load_dwordx4 v[16:19], v74, s[28:31], s54 offen offset:2048 sc1
    buffer_load_dwordx4 v[20:23], v74, s[28:31], s54 offen offset:3072 sc1
    buffer_load_dwordx4 v[24:27], v72, s[28:31], s54 offen sc1
    s_waitcnt vmcnt(27)
    v_mfma_f32_16x16x32_bf16 a[0:3], v[44:47], v[64:67], a[0:3]
    v_mfma_f32_16x16x32_bf16 a[4:7], v[44:47], v[68:71], a[4:7]
    v_mfma_f32_16x16x32_bf16 a[8:11], v[44:47], v[80:83], a[8:11]
    v_mfma_f32_16x16x32_bf16 a[12:15], v[44:47], v[84:87], a[12:15]
    v_mfma_f32_16x16x32_bf16 a[16:19], v[48:51], v[64:67], a[16:19]
    v_mfma_f32_16x16x32_bf16 a[20:23], v[48:51], v[68:71], a[20:23]
    v_mfma_f32_16x16x32_bf16 a[24:27], v[48:51], v[80:83], a[24:27]
    v_mfma_f32_16x16x32_bf16 a[28:31], v[48:51], v[84:87], a[28:31]
    v_mfma_f32_16x16x32_bf16 a[32:35], v[52:55], v[64:67], a[32:35]
    v_mfma_f32_16x16x32_bf16 a[36:39], v[52:55], v[68:71], a[36:39]
    v_mfma_f32_16x16x32_bf16 a[40:43], v[52:55], v[80:83], a[40:43]
    v_mfma_f32_16x16x32_bf16 a[44:47], v[52:55], v[84:87], a[44:47]
    v_mfma_f32_16x16x32_bf16 a[48:51], v[56:59], v[64:67], a[48:51]
    v_mfma_f32_16x16x32_bf16 a[52:55], v[56:59], v[68:71], a[52:55]
    v_mfma_f32_16x16x32_bf16 a[56:59], v[56:59], v[80:83], a[56:59]
    v_mfma_f32_16x16x32_bf16 a[60:63], v[56:59], v[84:87], a[60:63]
    v_mfma_f32_16x16x32_bf16 a[64:67], v[60:63], v[64:67], a[64:67]
    v_mfma_f32_16x16x32_bf16 a[68:71], v[60:63], v[68:71], a[68:71]
    v_mfma_f32_16x16x32_bf16 a[72:75], v[60:63], v[80:83], a[72:75]
    v_mfma_f32_16x16x32_bf16 a[76:79], v[60:63], v[84:87], a[76:79]
    s_add_u32 s55, s86, 114688
    buffer_load_dwordx4 v[64:67], v74, s[16:19], s55 offen offset:0 sc1
    buffer_load_dwordx4 v[68:71], v74, s[16:19], s55 offen offset:1024 sc1
    buffer_load_dwordx4 v[80:83], v74, s[16:19], s55 offen offset:2048 sc1
    buffer_load_dwordx4 v[84:87], v74, s[16:19], s55 offen offset:3072 sc1
    s_add_u32 s54, s85, 143360
    buffer_load_dwordx4 v[44:47], v74, s[28:31], s54 offen offset:0 sc1
    buffer_load_dwordx4 v[48:51], v74, s[28:31], s54 offen offset:1024 sc1
    buffer_load_dwordx4 v[52:55], v74, s[28:31], s54 offen offset:2048 sc1
    buffer_load_dwordx4 v[56:59], v74, s[28:31], s54 offen offset:3072 sc1
    buffer_load_dwordx4 v[60:63], v72, s[28:31], s54 offen sc1
    s_waitcnt vmcnt(27)
    v_mfma_f32_16x16x32_bf16 a[0:3], a[80:83], a[100:103], a[0:3]
    v_mfma_f32_16x16x32_bf16 a[4:7], a[80:83], a[104:107], a[4:7]
    v_mfma_f32_16x16x32_bf16 a[8:11], a[80:83], a[108:111], a[8:11]
    v_mfma_f32_16x16x32_bf16 a[12:15], a[80:83], a[112:115], a[12:15]
    v_mfma_f32_16x16x32_bf16 a[16:19], a[84:87], a[100:103], a[16:19]
    v_mfma_f32_16x16x32_bf16 a[20:23], a[84:87], a[104:107], a[20:23]
    v_mfma_f32_16x16x32_bf16 a[24:27], a[84:87], a[108:111], a[24:27]
    v_mfma_f32_16x16x32_bf16 a[28:31], a[84:87], a[112:115], a[28:31]
    v_mfma_f32_16x16x32_bf16 a[32:35], a[88:91], a[100:103], a[32:35]
    v_mfma_f32_16x16x32_bf16 a[36:39], a[88:91], a[104:107], a[36:39]
    v_mfma_f32_16x16x32_bf16 a[40:43], a[88:91], a[108:111], a[40:43]
    v_mfma_f32_16x16x32_bf16 a[44:47], a[88:91], a[112:115], a[44:47]
    v_mfma_f32_16x16x32_bf16 a[48:51], a[92:95], a[100:103], a[48:51]
    v_mfma_f32_16x16x32_bf16 a[52:55], a[92:95], a[104:107], a[52:55]
    v_mfma_f32_16x16x32_bf16 a[56:59], a[92:95], a[108:111], a[56:59]
    v_mfma_f32_16x16x32_bf16 a[60:63], a[92:95], a[112:115], a[60:63]
    v_mfma_f32_16x16x32_bf16 a[64:67], a[96:99], a[100:103], a[64:67]
    v_mfma_f32_16x16x32_bf16 a[68:71], a[96:99], a[104:107], a[68:71]
    v_mfma_f32_16x16x32_bf16 a[72:75], a[96:99], a[108:111], a[72:75]
    v_mfma_f32_16x16x32_bf16 a[76:79], a[96:99], a[112:115], a[76:79]
    s_add_u32 s55, s86, 131072
    buffer_load_dwordx4 a[100:103], v74, s[16:19], s55 offen offset:0 sc1
    buffer_load_dwordx4 a[104:107], v74, s[16:19], s55 offen offset:1024 sc1
    buffer_load_dwordx4 a[108:111], v74, s[16:19], s55 offen offset:2048 sc1
    buffer_load_dwordx4 a[112:115], v74, s[16:19], s55 offen offset:3072 sc1
    s_add_u32 s54, s85, 163840
    buffer_load_dwordx4 a[80:83], v74, s[28:31], s54 offen offset:0 sc1
    buffer_load_dwordx4 a[84:87], v74, s[28:31], s54 offen offset:1024 sc1
    buffer_load_dwordx4 a[88:91], v74, s[28:31], s54 offen offset:2048 sc1
    buffer_load_dwordx4 a[92:95], v74, s[28:31], s54 offen offset:3072 sc1
    buffer_load_dwordx4 a[96:99], v72, s[28:31], s54 offen sc1
    s_waitcnt vmcnt(27)
    v_mfma_f32_16x16x32_bf16 a[0:3], a[116:119], a[136:139], a[0:3]
    v_mfma_f32_16x16x32_bf16 a[4:7], a[116:119], a[140:143], a[4:7]
    v_mfma_f32_16x16x32_bf16 a[8:11], a[116:119], a[144:147], a[8:11]
    v_mfma_f32_16x16x32_bf16 a[12:15], a[116:119], a[148:151], a[12:15]
    v_mfma_f32_16x16x32_bf16 a[16:19], a[120:123], a[136:139], a[16:19]
    v_mfma_f32_16x16x32_bf16 a[20:23], a[120:123], a[140:143], a[20:23]
    v_mfma_f32_16x16x32_bf16 a[24:27], a[120:123], a[144:147], a[24:27]
    v_mfma_f32_16x16x32_bf16 a[28:31], a[120:123], a[148:151], a[28:31]
    v_mfma_f32_16x16x32_bf16 a[32:35], a[124:127], a[136:139], a[32:35]
    v_mfma_f32_16x16x32_bf16 a[36:39], a[124:127], a[140:143], a[36:39]
    v_mfma_f32_16x16x32_bf16 a[40:43], a[124:127], a[144:147], a[40:43]
    v_mfma_f32_16x16x32_bf16 a[44:47], a[124:127], a[148:151], a[44:47]
    v_mfma_f32_16x16x32_bf16 a[48:51], a[128:131], a[136:139], a[48:51]
    v_mfma_f32_16x16x32_bf16 a[52:55], a[128:131], a[140:143], a[52:55]
    v_mfma_f32_16x16x32_bf16 a[56:59], a[128:131], a[144:147], a[56:59]
    v_mfma_f32_16x16x32_bf16 a[60:63], a[128:131], a[148:151], a[60:63]
    v_mfma_f32_16x16x32_bf16 a[64:67], a[132:135], a[136:139], a[64:67]
    v_mfma_f32_16x16x32_bf16 a[68:71], a[132:135], a[140:143], a[68:71]
    v_mfma_f32_16x16x32_bf16 a[72:75], a[132:135], a[144:147], a[72:75]
    v_mfma_f32_16x16x32_bf16 a[76:79], a[132:135], a[148:151], a[76:79]
    s_add_u32 s55, s86, 147456
    buffer_load_dwordx4 a[136:139], v74, s[16:19], s55 offen offset:0 sc1
    buffer_load_dwordx4 a[140:143], v74, s[16:19], s55 offen offset:1024 sc1
    buffer_load_dwordx4 a[144:147], v74, s[16:19], s55 offen offset:2048 sc1
    buffer_load_dwordx4 a[148:151], v74, s[16:19], s55 offen offset:3072 sc1
    s_add_u32 s54, s85, 184320
    buffer_load_dwordx4 a[116:119], v74, s[28:31], s54 offen offset:0 sc1
    buffer_load_dwordx4 a[120:123], v74, s[28:31], s54 offen offset:1024 sc1
    buffer_load_dwordx4 a[124:127], v74, s[28:31], s54 offen offset:2048 sc1
    buffer_load_dwordx4 a[128:131], v74, s[28:31], s54 offen offset:3072 sc1
    buffer_load_dwordx4 a[132:135], v72, s[28:31], s54 offen sc1
    s_waitcnt vmcnt(27)
    v_mfma_f32_16x16x32_bf16 a[0:3], v[8:11], v[28:31], a[0:3]
    v_mfma_f32_16x16x32_bf16 a[4:7], v[8:11], v[32:35], a[4:7]
    v_mfma_f32_16x16x32_bf16 a[8:11], v[8:11], v[36:39], a[8:11]
    v_mfma_f32_16x16x32_bf16 a[12:15], v[8:11], v[40:43], a[12:15]
    v_mfma_f32_16x16x32_bf16 a[16:19], v[12:15], v[28:31], a[16:19]
    v_mfma_f32_16x16x32_bf16 a[20:23], v[12:15], v[32:35], a[20:23]
    v_mfma_f32_16x16x32_bf16 a[24:27], v[12:15], v[36:39], a[24:27]
    v_mfma_f32_16x16x32_bf16 a[28:31], v[12:15], v[40:43], a[28:31]
    v_mfma_f32_16x16x32_bf16 a[32:35], v[16:19], v[28:31], a[32:35]
    v_mfma_f32_16x16x32_bf16 a[36:39], v[16:19], v[32:35], a[36:39]
    v_mfma_f32_16x16x32_bf16 a[40:43], v[16:19], v[36:39], a[40:43]
    v_mfma_f32_16x16x32_bf16 a[44:47], v[16:19], v[40:43], a[44:47]
    v_mfma_f32_16x16x32_bf16 a[48:51], v[20:23], v[28:31], a[48:51]
    v_mfma_f32_16x16x32_bf16 a[52:55], v[20:23], v[32:35], a[52:55]
    v_mfma_f32_16x16x32_bf16 a[56:59], v[20:23], v[36:39], a[56:59]
    v_mfma_f32_16x16x32_bf16 a[60:63], v[20:23], v[40:43], a[60:63]
    v_mfma_f32_16x16x32_bf16 a[64:67], v[24:27], v[28:31], a[64:67]
    v_mfma_f32_16x16x32_bf16 a[68:71], v[24:27], v[32:35], a[68:71]
    v_mfma_f32_16x16x32_bf16 a[72:75], v[24:27], v[36:39], a[72:75]
    v_mfma_f32_16x16x32_bf16 a[76:79], v[24:27], v[40:43], a[76:79]
    s_add_u32 s55, s86, 163840
    buffer_load_dwordx4 v[28:31], v74, s[16:19], s55 offen offset:0 sc1
    buffer_load_dwordx4 v[32:35], v74, s[16:19], s55 offen offset:1024 sc1
    buffer_load_dwordx4 v[36:39], v74, s[16:19], s55 offen offset:2048 sc1
    buffer_load_dwordx4 v[40:43], v74, s[16:19], s55 offen offset:3072 sc1
    s_add_u32 s54, s85, 204800
    buffer_load_dwordx4 v[8:11], v74, s[28:31], s54 offen offset:0 sc1
    buffer_load_dwordx4 v[12:15], v74, s[28:31], s54 offen offset:1024 sc1
    buffer_load_dwordx4 v[16:19], v74, s[28:31], s54 offen offset:2048 sc1
    buffer_load_dwordx4 v[20:23], v74, s[28:31], s54 offen offset:3072 sc1
    buffer_load_dwordx4 v[24:27], v72, s[28:31], s54 offen sc1
    s_waitcnt vmcnt(27)
    v_mfma_f32_16x16x32_bf16 a[0:3], v[44:47], v[64:67], a[0:3]
    v_mfma_f32_16x16x32_bf16 a[4:7], v[44:47], v[68:71], a[4:7]
    v_mfma_f32_16x16x32_bf16 a[8:11], v[44:47], v[80:83], a[8:11]
    v_mfma_f32_16x16x32_bf16 a[12:15], v[44:47], v[84:87], a[12:15]
    v_mfma_f32_16x16x32_bf16 a[16:19], v[48:51], v[64:67], a[16:19]
    v_mfma_f32_16x16x32_bf16 a[20:23], v[48:51], v[68:71], a[20:23]
    v_mfma_f32_16x16x32_bf16 a[24:27], v[48:51], v[80:83], a[24:27]
    v_mfma_f32_16x16x32_bf16 a[28:31], v[48:51], v[84:87], a[28:31]
    v_mfma_f32_16x16x32_bf16 a[32:35], v[52:55], v[64:67], a[32:35]
    v_mfma_f32_16x16x32_bf16 a[36:39], v[52:55], v[68:71], a[36:39]
    v_mfma_f32_16x16x32_bf16 a[40:43], v[52:55], v[80:83], a[40:43]
    v_mfma_f32_16x16x32_bf16 a[44:47], v[52:55], v[84:87], a[44:47]
    v_mfma_f32_16x16x32_bf16 a[48:51], v[56:59], v[64:67], a[48:51]
    v_mfma_f32_16x16x32_bf16 a[52:55], v[56:59], v[68:71], a[52:55]
    v_mfma_f32_16x16x32_bf16 a[56:59], v[56:59], v[80:83], a[56:59]
    v_mfma_f32_16x16x32_bf16 a[60:63], v[56:59], v[84:87], a[60:63]
    v_mfma_f32_16x16x32_bf16 a[64:67], v[60:63], v[64:67], a[64:67]
    v_mfma_f32_16x16x32_bf16 a[68:71], v[60:63], v[68:71], a[68:71]
    v_mfma_f32_16x16x32_bf16 a[72:75], v[60:63], v[80:83], a[72:75]
    v_mfma_f32_16x16x32_bf16 a[76:79], v[60:63], v[84:87], a[76:79]
    s_add_u32 s55, s86, 180224
    buffer_load_dwordx4 v[64:67], v74, s[16:19], s55 offen offset:0 sc1
    buffer_load_dwordx4 v[68:71], v74, s[16:19], s55 offen offset:1024 sc1
    buffer_load_dwordx4 v[80:83], v74, s[16:19], s55 offen offset:2048 sc1
    buffer_load_dwordx4 v[84:87], v74, s[16:19], s55 offen offset:3072 sc1
    s_add_u32 s54, s85, 225280
    buffer_load_dwordx4 v[44:47], v74, s[28:31], s54 offen offset:0 sc1
    buffer_load_dwordx4 v[48:51], v74, s[28:31], s54 offen offset:1024 sc1
    buffer_load_dwordx4 v[52:55], v74, s[28:31], s54 offen offset:2048 sc1
    buffer_load_dwordx4 v[56:59], v74, s[28:31], s54 offen offset:3072 sc1
    buffer_load_dwordx4 v[60:63], v72, s[28:31], s54 offen sc1
    s_waitcnt vmcnt(27)
    v_mfma_f32_16x16x32_bf16 a[0:3], a[80:83], a[100:103], a[0:3]
    v_mfma_f32_16x16x32_bf16 a[4:7], a[80:83], a[104:107], a[4:7]
    v_mfma_f32_16x16x32_bf16 a[8:11], a[80:83], a[108:111], a[8:11]
    v_mfma_f32_16x16x32_bf16 a[12:15], a[80:83], a[112:115], a[12:15]
    v_mfma_f32_16x16x32_bf16 a[16:19], a[84:87], a[100:103], a[16:19]
    v_mfma_f32_16x16x32_bf16 a[20:23], a[84:87], a[104:107], a[20:23]
    v_mfma_f32_16x16x32_bf16 a[24:27], a[84:87], a[108:111], a[24:27]
    v_mfma_f32_16x16x32_bf16 a[28:31], a[84:87], a[112:115], a[28:31]
    v_mfma_f32_16x16x32_bf16 a[32:35], a[88:91], a[100:103], a[32:35]
    v_mfma_f32_16x16x32_bf16 a[36:39], a[88:91], a[104:107], a[36:39]
    v_mfma_f32_16x16x32_bf16 a[40:43], a[88:91], a[108:111], a[40:43]
    v_mfma_f32_16x16x32_bf16 a[44:47], a[88:91], a[112:115], a[44:47]
    v_mfma_f32_16x16x32_bf16 a[48:51], a[92:95], a[100:103], a[48:51]
    v_mfma_f32_16x16x32_bf16 a[52:55], a[92:95], a[104:107], a[52:55]
    v_mfma_f32_16x16x32_bf16 a[56:59], a[92:95], a[108:111], a[56:59]
    v_mfma_f32_16x16x32_bf16 a[60:63], a[92:95], a[112:115], a[60:63]
    v_mfma_f32_16x16x32_bf16 a[64:67], a[96:99], a[100:103], a[64:67]
    v_mfma_f32_16x16x32_bf16 a[68:71], a[96:99], a[104:107], a[68:71]
    v_mfma_f32_16x16x32_bf16 a[72:75], a[96:99], a[108:111], a[72:75]
    v_mfma_f32_16x16x32_bf16 a[76:79], a[96:99], a[112:115], a[76:79]
    s_add_u32 s55, s86, 196608
    buffer_load_dwordx4 a[100:103], v74, s[16:19], s55 offen offset:0 sc1
    buffer_load_dwordx4 a[104:107], v74, s[16:19], s55 offen offset:1024 sc1
    buffer_load_dwordx4 a[108:111], v74, s[16:19], s55 offen offset:2048 sc1
    buffer_load_dwordx4 a[112:115], v74, s[16:19], s55 offen offset:3072 sc1
    s_add_u32 s54, s85, 245760
    buffer_load_dwordx4 a[80:83], v74, s[28:31], s54 offen offset:0 sc1
    buffer_load_dwordx4 a[84:87], v74, s[28:31], s54 offen offset:1024 sc1
    buffer_load_dwordx4 a[88:91], v74, s[28:31], s54 offen offset:2048 sc1
    buffer_load_dwordx4 a[92:95], v74, s[28:31], s54 offen offset:3072 sc1
    buffer_load_dwordx4 a[96:99], v72, s[28:31], s54 offen sc1
    s_waitcnt vmcnt(27)
    v_mfma_f32_16x16x32_bf16 a[0:3], a[116:119], a[136:139], a[0:3]
    v_mfma_f32_16x16x32_bf16 a[4:7], a[116:119], a[140:143], a[4:7]
    v_mfma_f32_16x16x32_bf16 a[8:11], a[116:119], a[144:147], a[8:11]
    v_mfma_f32_16x16x32_bf16 a[12:15], a[116:119], a[148:151], a[12:15]
    v_mfma_f32_16x16x32_bf16 a[16:19], a[120:123], a[136:139], a[16:19]
    v_mfma_f32_16x16x32_bf16 a[20:23], a[120:123], a[140:143], a[20:23]
    v_mfma_f32_16x16x32_bf16 a[24:27], a[120:123], a[144:147], a[24:27]
    v_mfma_f32_16x16x32_bf16 a[28:31], a[120:123], a[148:151], a[28:31]
    v_mfma_f32_16x16x32_bf16 a[32:35], a[124:127], a[136:139], a[32:35]
    v_mfma_f32_16x16x32_bf16 a[36:39], a[124:127], a[140:143], a[36:39]
    v_mfma_f32_16x16x32_bf16 a[40:43], a[124:127], a[144:147], a[40:43]
    v_mfma_f32_16x16x32_bf16 a[44:47], a[124:127], a[148:151], a[44:47]
    v_mfma_f32_16x16x32_bf16 a[48:51], a[128:131], a[136:139], a[48:51]
    v_mfma_f32_16x16x32_bf16 a[52:55], a[128:131], a[140:143], a[52:55]
    v_mfma_f32_16x16x32_bf16 a[56:59], a[128:131], a[144:147], a[56:59]
    v_mfma_f32_16x16x32_bf16 a[60:63], a[128:131], a[148:151], a[60:63]
    v_mfma_f32_16x16x32_bf16 a[64:67], a[132:135], a[136:139], a[64:67]
    v_mfma_f32_16x16x32_bf16 a[68:71], a[132:135], a[140:143], a[68:71]
    v_mfma_f32_16x16x32_bf16 a[72:75], a[132:135], a[144:147], a[72:75]
    v_mfma_f32_16x16x32_bf16 a[76:79], a[132:135], a[148:151], a[76:79]
    s_cmp_ge_u32 s41, 2
    s_cbranch_scc1 parallel_sum__linear_kernel_hedgehog__dense_activation_squared_relu__prompt_kernel_o_64
    s_add_u32 s55, s86, 212992
    buffer_load_dwordx4 a[136:139], v74, s[16:19], s55 offen offset:0 sc1
    buffer_load_dwordx4 a[140:143], v74, s[16:19], s55 offen offset:1024 sc1
    buffer_load_dwordx4 a[144:147], v74, s[16:19], s55 offen offset:2048 sc1
    buffer_load_dwordx4 a[148:151], v74, s[16:19], s55 offen offset:3072 sc1
    s_add_u32 s54, s85, 266240
    buffer_load_dwordx4 a[116:119], v74, s[28:31], s54 offen offset:0 sc1
    buffer_load_dwordx4 a[120:123], v74, s[28:31], s54 offen offset:1024 sc1
    buffer_load_dwordx4 a[124:127], v74, s[28:31], s54 offen offset:2048 sc1
    buffer_load_dwordx4 a[128:131], v74, s[28:31], s54 offen offset:3072 sc1
    buffer_load_dwordx4 a[132:135], v72, s[28:31], s54 offen sc1
parallel_sum__linear_kernel_hedgehog__dense_activation_squared_relu__prompt_kernel_o_64:
    s_waitcnt vmcnt(18)
    v_mfma_f32_16x16x32_bf16 a[0:3], v[8:11], v[28:31], a[0:3]
    v_mfma_f32_16x16x32_bf16 a[4:7], v[8:11], v[32:35], a[4:7]
    v_mfma_f32_16x16x32_bf16 a[8:11], v[8:11], v[36:39], a[8:11]
    v_mfma_f32_16x16x32_bf16 a[12:15], v[8:11], v[40:43], a[12:15]
    v_mfma_f32_16x16x32_bf16 a[16:19], v[12:15], v[28:31], a[16:19]
    v_mfma_f32_16x16x32_bf16 a[20:23], v[12:15], v[32:35], a[20:23]
    v_mfma_f32_16x16x32_bf16 a[24:27], v[12:15], v[36:39], a[24:27]
    v_mfma_f32_16x16x32_bf16 a[28:31], v[12:15], v[40:43], a[28:31]
    v_mfma_f32_16x16x32_bf16 a[32:35], v[16:19], v[28:31], a[32:35]
    v_mfma_f32_16x16x32_bf16 a[36:39], v[16:19], v[32:35], a[36:39]
    v_mfma_f32_16x16x32_bf16 a[40:43], v[16:19], v[36:39], a[40:43]
    v_mfma_f32_16x16x32_bf16 a[44:47], v[16:19], v[40:43], a[44:47]
    v_mfma_f32_16x16x32_bf16 a[48:51], v[20:23], v[28:31], a[48:51]
    v_mfma_f32_16x16x32_bf16 a[52:55], v[20:23], v[32:35], a[52:55]
    v_mfma_f32_16x16x32_bf16 a[56:59], v[20:23], v[36:39], a[56:59]
    v_mfma_f32_16x16x32_bf16 a[60:63], v[20:23], v[40:43], a[60:63]
    v_mfma_f32_16x16x32_bf16 a[64:67], v[24:27], v[28:31], a[64:67]
    v_mfma_f32_16x16x32_bf16 a[68:71], v[24:27], v[32:35], a[68:71]
    v_mfma_f32_16x16x32_bf16 a[72:75], v[24:27], v[36:39], a[72:75]
    v_mfma_f32_16x16x32_bf16 a[76:79], v[24:27], v[40:43], a[76:79]
    s_waitcnt vmcnt(9)
    v_mfma_f32_16x16x32_bf16 a[0:3], v[44:47], v[64:67], a[0:3]
    v_mfma_f32_16x16x32_bf16 a[4:7], v[44:47], v[68:71], a[4:7]
    v_mfma_f32_16x16x32_bf16 a[8:11], v[44:47], v[80:83], a[8:11]
    v_mfma_f32_16x16x32_bf16 a[12:15], v[44:47], v[84:87], a[12:15]
    v_mfma_f32_16x16x32_bf16 a[16:19], v[48:51], v[64:67], a[16:19]
    v_mfma_f32_16x16x32_bf16 a[20:23], v[48:51], v[68:71], a[20:23]
    v_mfma_f32_16x16x32_bf16 a[24:27], v[48:51], v[80:83], a[24:27]
    v_mfma_f32_16x16x32_bf16 a[28:31], v[48:51], v[84:87], a[28:31]
    v_mfma_f32_16x16x32_bf16 a[32:35], v[52:55], v[64:67], a[32:35]
    v_mfma_f32_16x16x32_bf16 a[36:39], v[52:55], v[68:71], a[36:39]
    v_mfma_f32_16x16x32_bf16 a[40:43], v[52:55], v[80:83], a[40:43]
    v_mfma_f32_16x16x32_bf16 a[44:47], v[52:55], v[84:87], a[44:47]
    v_mfma_f32_16x16x32_bf16 a[48:51], v[56:59], v[64:67], a[48:51]
    v_mfma_f32_16x16x32_bf16 a[52:55], v[56:59], v[68:71], a[52:55]
    v_mfma_f32_16x16x32_bf16 a[56:59], v[56:59], v[80:83], a[56:59]
    v_mfma_f32_16x16x32_bf16 a[60:63], v[56:59], v[84:87], a[60:63]
    v_mfma_f32_16x16x32_bf16 a[64:67], v[60:63], v[64:67], a[64:67]
    v_mfma_f32_16x16x32_bf16 a[68:71], v[60:63], v[68:71], a[68:71]
    v_mfma_f32_16x16x32_bf16 a[72:75], v[60:63], v[80:83], a[72:75]
    v_mfma_f32_16x16x32_bf16 a[76:79], v[60:63], v[84:87], a[76:79]
    s_mov_b32 s36, s70
    s_mov_b32 s37, s71
    s_mov_b32 s38, 1280
    s_mov_b32 s12, s72
    s_mov_b32 s13, s73
    s_mov_b32 s14, 2621440
    v_lshrrev_b32 v2, 4, v1
    v_mul_u32_u24 v77, 40, v2
    s_mul_i32 s54, s46, 160
    s_mul_i32 s55, s42, 24
    s_add_u32 s54, s54, s55
    v_add_u32 v77, s54, v77
    v_and_b32 v2, 15, v1
    s_lshl_b32 s54, s45, 6
    s_lshl_b32 s55, s41, 4
    s_add_u32 s54, s54, s55
    v_add_u32 v2, s54, v2
    v_mul_u32_u24 v76, 1280, v2
    v_add_u32 v76, v76, v77
    buffer_load_dwordx4 v[80:83], v76, s[8:11], 0 offen
    buffer_load_dwordx2 v[84:85], v76, s[8:11], 0 offen offset:16
    buffer_load_dwordx4 v[88:91], v77, s[36:39], 0 offen
    buffer_load_dwordx2 v[92:93], v77, s[36:39], 0 offen offset:16
    s_waitcnt vmcnt(4)
    v_mfma_f32_16x16x32_bf16 a[0:3], a[80:83], a[100:103], a[0:3]
    v_mfma_f32_16x16x32_bf16 a[4:7], a[80:83], a[104:107], a[4:7]
    v_mfma_f32_16x16x32_bf16 a[8:11], a[80:83], a[108:111], a[8:11]
    v_mfma_f32_16x16x32_bf16 a[12:15], a[80:83], a[112:115], a[12:15]
    v_mfma_f32_16x16x32_bf16 a[16:19], a[84:87], a[100:103], a[16:19]
    v_mfma_f32_16x16x32_bf16 a[20:23], a[84:87], a[104:107], a[20:23]
    v_mfma_f32_16x16x32_bf16 a[24:27], a[84:87], a[108:111], a[24:27]
    v_mfma_f32_16x16x32_bf16 a[28:31], a[84:87], a[112:115], a[28:31]
    v_mfma_f32_16x16x32_bf16 a[32:35], a[88:91], a[100:103], a[32:35]
    v_mfma_f32_16x16x32_bf16 a[36:39], a[88:91], a[104:107], a[36:39]
    v_mfma_f32_16x16x32_bf16 a[40:43], a[88:91], a[108:111], a[40:43]
    v_mfma_f32_16x16x32_bf16 a[44:47], a[88:91], a[112:115], a[44:47]
    v_mfma_f32_16x16x32_bf16 a[48:51], a[92:95], a[100:103], a[48:51]
    v_mfma_f32_16x16x32_bf16 a[52:55], a[92:95], a[104:107], a[52:55]
    v_mfma_f32_16x16x32_bf16 a[56:59], a[92:95], a[108:111], a[56:59]
    v_mfma_f32_16x16x32_bf16 a[60:63], a[92:95], a[112:115], a[60:63]
    v_mfma_f32_16x16x32_bf16 a[64:67], a[96:99], a[100:103], a[64:67]
    v_mfma_f32_16x16x32_bf16 a[68:71], a[96:99], a[104:107], a[68:71]
    v_mfma_f32_16x16x32_bf16 a[72:75], a[96:99], a[108:111], a[72:75]
    v_mfma_f32_16x16x32_bf16 a[76:79], a[96:99], a[112:115], a[76:79]
    s_cmp_ge_u32 s41, 2
    s_cbranch_scc1 parallel_sum__linear_kernel_hedgehog__dense_activation_squared_relu__prompt_kernel_o_65
    s_waitcnt vmcnt(4)
    v_mfma_f32_16x16x32_bf16 a[0:3], a[116:119], a[136:139], a[0:3]
    v_mfma_f32_16x16x32_bf16 a[4:7], a[116:119], a[140:143], a[4:7]
    v_mfma_f32_16x16x32_bf16 a[8:11], a[116:119], a[144:147], a[8:11]
    v_mfma_f32_16x16x32_bf16 a[12:15], a[116:119], a[148:151], a[12:15]
    v_mfma_f32_16x16x32_bf16 a[16:19], a[120:123], a[136:139], a[16:19]
    v_mfma_f32_16x16x32_bf16 a[20:23], a[120:123], a[140:143], a[20:23]
    v_mfma_f32_16x16x32_bf16 a[24:27], a[120:123], a[144:147], a[24:27]
    v_mfma_f32_16x16x32_bf16 a[28:31], a[120:123], a[148:151], a[28:31]
    v_mfma_f32_16x16x32_bf16 a[32:35], a[124:127], a[136:139], a[32:35]
    v_mfma_f32_16x16x32_bf16 a[36:39], a[124:127], a[140:143], a[36:39]
    v_mfma_f32_16x16x32_bf16 a[40:43], a[124:127], a[144:147], a[40:43]
    v_mfma_f32_16x16x32_bf16 a[44:47], a[124:127], a[148:151], a[44:47]
    v_mfma_f32_16x16x32_bf16 a[48:51], a[128:131], a[136:139], a[48:51]
    v_mfma_f32_16x16x32_bf16 a[52:55], a[128:131], a[140:143], a[52:55]
    v_mfma_f32_16x16x32_bf16 a[56:59], a[128:131], a[144:147], a[56:59]
    v_mfma_f32_16x16x32_bf16 a[60:63], a[128:131], a[148:151], a[60:63]
    v_mfma_f32_16x16x32_bf16 a[64:67], a[132:135], a[136:139], a[64:67]
    v_mfma_f32_16x16x32_bf16 a[68:71], a[132:135], a[140:143], a[68:71]
    v_mfma_f32_16x16x32_bf16 a[72:75], a[132:135], a[144:147], a[72:75]
    v_mfma_f32_16x16x32_bf16 a[76:79], a[132:135], a[148:151], a[76:79]
parallel_sum__linear_kernel_hedgehog__dense_activation_squared_relu__prompt_kernel_o_65:
    s_waitcnt vmcnt(0)
    v_lshlrev_b32 v60, 16, v80
    v_and_b32 v61, 0xffff0000, v80
    v_lshlrev_b32 v2, 16, v88
    v_and_b32 v3, 0xffff0000, v88
    v_add_f32 v60, v60, v2
    v_add_f32 v61, v61, v3
    v_lshlrev_b32 v62, 16, v81
    v_and_b32 v63, 0xffff0000, v81
    v_lshlrev_b32 v2, 16, v89
    v_and_b32 v3, 0xffff0000, v89
    v_add_f32 v62, v62, v2
    v_add_f32 v63, v63, v3
    v_lshlrev_b32 v64, 16, v82
    v_and_b32 v65, 0xffff0000, v82
    v_lshlrev_b32 v2, 16, v90
    v_and_b32 v3, 0xffff0000, v90
    v_add_f32 v64, v64, v2
    v_add_f32 v65, v65, v3
    v_lshlrev_b32 v66, 16, v83
    v_and_b32 v67, 0xffff0000, v83
    v_lshlrev_b32 v2, 16, v91
    v_and_b32 v3, 0xffff0000, v91
    v_add_f32 v66, v66, v2
    v_add_f32 v67, v67, v3
    v_lshlrev_b32 v68, 16, v84
    v_and_b32 v69, 0xffff0000, v84
    v_lshlrev_b32 v2, 16, v92
    v_and_b32 v3, 0xffff0000, v92
    v_add_f32 v68, v68, v2
    v_add_f32 v69, v69, v3
    v_lshlrev_b32 v70, 16, v85
    v_and_b32 v71, 0xffff0000, v85
    v_lshlrev_b32 v2, 16, v93
    v_and_b32 v3, 0xffff0000, v93
    v_add_f32 v70, v70, v2
    v_add_f32 v71, v71, v3
    s_mul_i32 s54, s40, 20480
    v_add_u32 v78, s54, v74
    ds_write_b128 v78, a[0:3] offset:0
    ds_write_b128 v78, a[16:19] offset:1024
    ds_write_b128 v78, a[32:35] offset:2048
    ds_write_b128 v78, a[48:51] offset:3072
    ds_write_b128 v78, a[64:67] offset:4096
    ds_write_b128 v78, a[4:7] offset:5120
    ds_write_b128 v78, a[20:23] offset:6144
    ds_write_b128 v78, a[36:39] offset:7168
    ds_write_b128 v78, a[52:55] offset:8192
    ds_write_b128 v78, a[68:71] offset:9216
    ds_write_b128 v78, a[8:11] offset:10240
    ds_write_b128 v78, a[24:27] offset:11264
    ds_write_b128 v78, a[40:43] offset:12288
    ds_write_b128 v78, a[56:59] offset:13312
    ds_write_b128 v78, a[72:75] offset:14336
    ds_write_b128 v78, a[12:15] offset:15360
    ds_write_b128 v78, a[28:31] offset:16384
    ds_write_b128 v78, a[44:47] offset:17408
    ds_write_b128 v78, a[60:63] offset:18432
    ds_write_b128 v78, a[76:79] offset:19456
    s_waitcnt lgkmcnt(0)
    s_branch parallel_sum__linear_kernel_hedgehog__dense_activation_squared_relu__prompt_kernel_join2
parallel_sum__linear_kernel_hedgehog__dense_activation_squared_relu__prompt_kernel_chain:
    s_and_b32 s52, s40, 1
    s_lshr_b32 s53, s40, 1
    v_bfe_u32 v2, v1, 2, 2
    v_lshl_add_u32 v2, v6, 3, v2
    v_bfe_u32 v3, v1, 4, 1
    v_and_b32 v4, 3, v1
    v_lshl_add_u32 v3, v3, 2, v4
    v_lshlrev_b32 v3, 3, v3
    v_mul_u32_u24 v88, 96, v2
    v_add_u32 v88, v88, v3
    s_mul_i32 s54, s52, 48
    s_add_u32 s54, s54, 49152
    v_add_u32 v88, s54, v88
    v_mul_u32_u24 v89, 160, v2
    v_add_u32 v89, v89, v3
    s_mul_i32 s54, s52, 80
    s_lshl_b32 s55, s53, 6
    s_add_u32 s54, s54, s55
    s_add_u32 s54, s54, 8192
    v_add_u32 v89, s54, v89
    ds_read_b64_tr_b16 v[8:9], v88 offset:0
    ds_read_b64_tr_b16 v[12:13], v89 offset:0
    ds_read_b64_tr_b16 v[10:11], v88 offset:384
    ds_read_b64_tr_b16 v[14:15], v89 offset:640
    ds_read_b64_tr_b16 v[16:17], v88 offset:1536
    ds_read_b64_tr_b16 v[20:21], v89 offset:2560
    ds_read_b64_tr_b16 v[18:19], v88 offset:1920
    ds_read_b64_tr_b16 v[22:23], v89 offset:3200
    ds_read_b64_tr_b16 v[24:25], v88 offset:3072
    ds_read_b64_tr_b16 v[28:29], v89 offset:5120
    ds_read_b64_tr_b16 v[26:27], v88 offset:3456
    ds_read_b64_tr_b16 v[30:31], v89 offset:5760
    s_waitcnt lgkmcnt(8)
    v_mfma_f32_32x32x16_bf16 v[44:59], v[8:11], v[12:15], 0
    ds_read_b64_tr_b16 v[32:33], v88 offset:4608
    ds_read_b64_tr_b16 v[36:37], v89 offset:7680
    ds_read_b64_tr_b16 v[34:35], v88 offset:4992
    ds_read_b64_tr_b16 v[38:39], v89 offset:8320
    s_waitcnt lgkmcnt(8)
    v_mfma_f32_32x32x16_bf16 v[44:59], v[16:19], v[20:23], v[44:59]
    ds_read_b64_tr_b16 v[8:9], v88 offset:6144
    ds_read_b64_tr_b16 v[12:13], v89 offset:10240
    ds_read_b64_tr_b16 v[10:11], v88 offset:6528
    ds_read_b64_tr_b16 v[14:15], v89 offset:10880
    s_waitcnt lgkmcnt(8)
    v_mfma_f32_32x32x16_bf16 v[44:59], v[24:27], v[28:31], v[44:59]
    ds_read_b64_tr_b16 v[16:17], v88 offset:7680
    ds_read_b64_tr_b16 v[20:21], v89 offset:12800
    ds_read_b64_tr_b16 v[18:19], v88 offset:8064
    ds_read_b64_tr_b16 v[22:23], v89 offset:13440
    s_waitcnt lgkmcnt(8)
    v_mfma_f32_32x32x16_bf16 v[44:59], v[32:35], v[36:39], v[44:59]
    ds_read_b64_tr_b16 v[24:25], v88 offset:9216
    ds_read_b64_tr_b16 v[28:29], v89 offset:15360
    ds_read_b64_tr_b16 v[26:27], v88 offset:9600
    ds_read_b64_tr_b16 v[30:31], v89 offset:16000
    s_waitcnt lgkmcnt(8)
    v_mfma_f32_32x32x16_bf16 v[44:59], v[8:11], v[12:15], v[44:59]
    ds_read_b64_tr_b16 v[32:33], v88 offset:10752
    ds_read_b64_tr_b16 v[36:37], v89 offset:17920
    ds_read_b64_tr_b16 v[34:35], v88 offset:11136
    ds_read_b64_tr_b16 v[38:39], v89 offset:18560
    s_waitcnt lgkmcnt(8)
    v_mfma_f32_32x32x16_bf16 v[44:59], v[16:19], v[20:23], v[44:59]
    s_waitcnt lgkmcnt(4)
    v_mfma_f32_32x32x16_bf16 v[44:59], v[24:27], v[28:31], v[44:59]
    s_waitcnt lgkmcnt(0)
    v_mfma_f32_32x32x16_bf16 v[44:59], v[32:35], v[36:39], v[44:59]
    s_lshl_b32 s54, s43, 4
    s_add_u32 s54, s54, s44
    s_lshl_b32 s54, s54, 1
    s_add_u32 s54, s54, s52
    s_mul_i32 s54, s54, 3360
    v_and_b32 v2, 31, v1
    s_lshl_b32 s55, s53, 5
    v_add_u32 v2, s55, v2
    v_lshlrev_b32 v3, 2, v2
    v_mul_u32_u24 v4, 640, v6
    v_add_u32 v3, v3, v4
    v_mov_b32 v4, 0x7fffff00
    v_cmp_gt_u32 vcc, 40, v2
    s_nop 1
    v_cndmask_b32 v3, v4, v3, vcc
    buffer_store_dword v44, v3, s[20:23], s54 offen offset:0 sc1
    buffer_store_dword v45, v3, s[20:23], s54 offen offset:160 sc1
    buffer_store_dword v46, v3, s[20:23], s54 offen offset:320 sc1
    buffer_store_dword v47, v3, s[20:23], s54 offen offset:480 sc1
    buffer_store_dword v48, v3, s[20:23], s54 offen offset:1280 sc1
    buffer_store_dword v49, v3, s[20:23], s54 offen offset:1440 sc1
    buffer_store_dword v50, v3, s[20:23], s54 offen offset:1600 sc1
    buffer_store_dword v51, v3, s[20:23], s54 offen offset:1760 sc1
    buffer_store_dword v52, v3, s[20:23], s54 offen offset:2560 sc1
    v_cndmask_b32 v3, v3, v4, s[80:81]
    buffer_store_dword v53, v3, s[20:23], s54 offen offset:2720 sc1
    buffer_store_dword v54, v3, s[20:23], s54 offen offset:2880 sc1
    buffer_store_dword v55, v3, s[20:23], s54 offen offset:3040 sc1
    s_waitcnt vmcnt(0)
    s_lshl_b32 s54, s44, 8
    s_lshl_b32 s55, s43, 4
    s_add_u32 s54, s54, s55
    s_lshl_b32 s55, s40, 2
    s_add_u32 s54, s54, s55
    s_add_u32 s54, s54, 8192
    v_mov_b32 v2, s54
    v_mov_b32 v3, s82
    buffer_store_dword v3, v2, s[32:35], 0 offen sc1
    s_add_u32 s54, s85, 276480
    buffer_load_dwordx4 a[80:83], v74, s[28:31], s54 offen offset:0 sc1
    buffer_load_dwordx4 a[84:87], v74, s[28:31], s54 offen offset:1024 sc1
    buffer_load_dwordx4 a[88:91], v74, s[28:31], s54 offen offset:2048 sc1
    buffer_load_dwordx4 a[92:95], v74, s[28:31], s54 offen offset:3072 sc1
    buffer_load_dwordx4 a[96:99], v72, s[28:31], s54 offen sc1
    s_add_u32 s54, s85, 296960
    buffer_load_dwordx4 a[116:119], v74, s[28:31], s54 offen offset:0 sc1
    buffer_load_dwordx4 a[120:123], v74, s[28:31], s54 offen offset:1024 sc1
    buffer_load_dwordx4 a[124:127], v74, s[28:31], s54 offen offset:2048 sc1
    buffer_load_dwordx4 a[128:131], v74, s[28:31], s54 offen offset:3072 sc1
    buffer_load_dwordx4 a[132:135], v72, s[28:31], s54 offen sc1
    s_add_u32 s54, s85, 317440
    buffer_load_dwordx4 v[8:11], v74, s[28:31], s54 offen offset:0 sc1
    buffer_load_dwordx4 v[12:15], v74, s[28:31], s54 offen offset:1024 sc1
    buffer_load_dwordx4 v[16:19], v74, s[28:31], s54 offen offset:2048 sc1
    buffer_load_dwordx4 v[20:23], v74, s[28:31], s54 offen offset:3072 sc1
    buffer_load_dwordx4 v[24:27], v72, s[28:31], s54 offen sc1
    v_lshlrev_b32 v88, 2, v1
    s_cmp_lg_u32 s40, 0
    s_cbranch_scc1 parallel_sum__linear_kernel_hedgehog__dense_activation_squared_relu__prompt_kernel_o_66
    s_lshl_b32 s54, s44, 8
    s_add_u32 s54, s54, 8192
    buffer_load_dword v44, v88, s[32:35], s54 offen sc1
    s_waitcnt vmcnt(0)
    s_mov_b32 s52, 0x40000
parallel_sum__linear_kernel_hedgehog__dense_activation_squared_relu__prompt_kernel_sp_67:
    v_cmp_ne_u32 vcc, s82, v44
    s_nop 4
    s_cbranch_vccz parallel_sum__linear_kernel_hedgehog__dense_activation_squared_relu__prompt_kernel_sd_68
    s_sub_u32 s52, s52, 1
    s_cmp_eq_u32 s52, 0
    s_cbranch_scc1 parallel_sum__linear_kernel_hedgehog__dense_activation_squared_relu__prompt_kernel_sd_68
    s_sleep 8
    s_lshl_b32 s54, s44, 8
    s_add_u32 s54, s54, 8192
    buffer_load_dword v44, v88, s[32:35], s54 offen sc1
    s_waitcnt vmcnt(0)
    s_branch parallel_sum__linear_kernel_hedgehog__dense_activation_squared_relu__prompt_kernel_sp_67
parallel_sum__linear_kernel_hedgehog__dense_activation_squared_relu__prompt_kernel_sd_68:
parallel_sum__linear_kernel_hedgehog__dense_activation_squared_relu__prompt_kernel_o_66:
    s_waitcnt lgkmcnt(0)
    v_mov_b32 v2, 272
    v_mov_b32 v3, 1
    s_mov_b64 s[56:57], exec
    s_mov_b64 exec, 1
    ds_add_u32 v2, v3
    s_mov_b64 exec, s[56:57]
    s_mov_b32 s52, 0x400000
parallel_sum__linear_kernel_hedgehog__dense_activation_squared_relu__prompt_kernel_s4_69:
    ds_read_b32 v3, v2
    s_waitcnt lgkmcnt(0)
    v_readfirstlane_b32 s53, v3
    s_nop 1
    s_cmp_ge_u32 s53, 4
    s_cbranch_scc1 parallel_sum__linear_kernel_hedgehog__dense_activation_squared_relu__prompt_kernel_s4d_70
    s_sub_u32 s52, s52, 1
    s_cmp_eq_u32 s52, 0
    s_cbranch_scc1 parallel_sum__linear_kernel_hedgehog__dense_activation_squared_relu__prompt_kernel_s4d_70
    s_sleep 1
    s_branch parallel_sum__linear_kernel_hedgehog__dense_activation_squared_relu__prompt_kernel_s4_69
parallel_sum__linear_kernel_hedgehog__dense_activation_squared_relu__prompt_kernel_s4d_70:
    v_lshlrev_b32 v2, 4, v0
    v_add_u32 v4, 0x1000, v2
    v_mov_b32 v3, 0x7fffff00
    v_cmp_gt_u32 vcc, 164, v0
    s_nop 1
    v_cndmask_b32 v4, v3, v4, vcc
    s_mul_i32 s54, s44, 6720
    buffer_load_dwordx4 a[0:3], v2, s[20:23], s54 offen sc1
    buffer_load_dwordx4 v[44:47], v4, s[20:23], s54 offen sc1
    s_add_u32 s54, s54, 107520
    buffer_load_dwordx4 a[4:7], v2, s[20:23], s54 offen sc1
    buffer_load_dwordx4 v[48:51], v4, s[20:23], s54 offen sc1
    s_add_u32 s54, s54, 107520
    buffer_load_dwordx4 a[8:11], v2, s[20:23], s54 offen sc1
    buffer_load_dwordx4 v[52:55], v4, s[20:23], s54 offen sc1
    s_add_u32 s54, s54, 107520
    buffer_load_dwordx4 a[12:15], v2, s[20:23], s54 offen sc1
    buffer_load_dwordx4 v[56:59], v4, s[20:23], s54 offen sc1
    s_add_u32 s54, s54, 107520
    buffer_load_dwordx4 a[16:19], v2, s[20:23], s54 offen sc1
    buffer_load_dwordx4 v[60:63], v4, s[20:23], s54 offen sc1
    s_add_u32 s54, s54, 107520
    buffer_load_dwordx4 a[20:23], v2, s[20:23], s54 offen sc1
    buffer_load_dwordx4 v[64:67], v4, s[20:23], s54 offen sc1
    s_add_u32 s54, s54, 107520
    buffer_load_dwordx4 a[24:27], v2, s[20:23], s54 offen sc1
    buffer_load_dwordx4 v[68:71], v4, s[20:23], s54 offen sc1
    s_add_u32 s54, s54, 107520
    buffer_load_dwordx4 a[28:31], v2, s[20:23], s54 offen sc1
    buffer_load_dwordx4 v[80:83], v4, s[20:23], s54 offen sc1
    s_add_u32 s54, s54, 107520
    buffer_load_dwordx4 a[32:35], v2, s[20:23], s54 offen sc1
    buffer_load_dwordx4 v[84:87], v4, s[20:23], s54 offen sc1
    s_add_u32 s54, s54, 107520
    buffer_load_dwordx4 a[36:39], v2, s[20:23], s54 offen sc1
    buffer_load_dwordx4 v[88:91], v4, s[20:23], s54 offen sc1
    s_add_u32 s54, s54, 107520
    buffer_load_dwordx4 a[40:43], v2, s[20:23], s54 offen sc1
    buffer_load_dwordx4 v[92:95], v4, s[20:23], s54 offen sc1
    s_add_u32 s54, s54, 107520
    buffer_load_dwordx4 a[44:47], v2, s[20:23], s54 offen sc1
    buffer_load_dwordx4 a[64:67], v4, s[20:23], s54 offen sc1
    s_add_u32 s54, s54, 107520
    buffer_load_dwordx4 a[48:51], v2, s[20:23], s54 offen sc1
    buffer_load_dwordx4 a[68:71], v4, s[20:23], s54 offen sc1
    s_add_u32 s54, s54, 107520
    buffer_load_dwordx4 a[52:55], v2, s[20:23], s54 offen sc1
    buffer_load_dwordx4 a[72:75], v4, s[20:23], s54 offen sc1
    s_add_u32 s54, s54, 107520
    buffer_load_dwordx4 a[56:59], v2, s[20:23], s54 offen sc1
    buffer_load_dwordx4 a[76:79], v4, s[20:23], s54 offen sc1
    s_add_u32 s54, s54, 107520
    buffer_load_dwordx4 a[60:63], v2, s[20:23], s54 offen sc1
    buffer_load_dwordx4 a[152:155], v4, s[20:23], s54 offen sc1
    s_waitcnt vmcnt(0)
    v_accvgpr_read_b32 v76, a0
    v_accvgpr_read_b32 v77, a1
    v_accvgpr_read_b32 v78, a2
    v_accvgpr_read_b32 v79, a3
    v_accvgpr_read_b32 v2, a4
    v_accvgpr_read_b32 v3, a5
    v_accvgpr_read_b32 v4, a6
    v_accvgpr_read_b32 v5, a7
    v_pk_add_f32 v[76:77], v[76:77], v[2:3]
    v_pk_add_f32 v[78:79], v[78:79], v[4:5]
    v_accvgpr_read_b32 v2, a8
    v_accvgpr_read_b32 v3, a9
    v_accvgpr_read_b32 v4, a10
    v_accvgpr_read_b32 v5, a11
    v_pk_add_f32 v[76:77], v[76:77], v[2:3]
    v_pk_add_f32 v[78:79], v[78:79], v[4:5]
    v_accvgpr_read_b32 v2, a12
    v_accvgpr_read_b32 v3, a13
    v_accvgpr_read_b32 v4, a14
    v_accvgpr_read_b32 v5, a15
    v_pk_add_f32 v[76:77], v[76:77], v[2:3]
    v_pk_add_f32 v[78:79], v[78:79], v[4:5]
    v_accvgpr_read_b32 v2, a16
    v_accvgpr_read_b32 v3, a17
    v_accvgpr_read_b32 v4, a18
    v_accvgpr_read_b32 v5, a19
    v_pk_add_f32 v[76:77], v[76:77], v[2:3]
    v_pk_add_f32 v[78:79], v[78:79], v[4:5]
    v_accvgpr_read_b32 v2, a20
    v_accvgpr_read_b32 v3, a21
    v_accvgpr_read_b32 v4, a22
    v_accvgpr_read_b32 v5, a23
    v_pk_add_f32 v[76:77], v[76:77], v[2:3]
    v_pk_add_f32 v[78:79], v[78:79], v[4:5]
    v_accvgpr_read_b32 v2, a24
    v_accvgpr_read_b32 v3, a25
    v_accvgpr_read_b32 v4, a26
    v_accvgpr_read_b32 v5, a27
    v_pk_add_f32 v[76:77], v[76:77], v[2:3]
    v_pk_add_f32 v[78:79], v[78:79], v[4:5]
    v_accvgpr_read_b32 v2, a28
    v_accvgpr_read_b32 v3, a29
    v_accvgpr_read_b32 v4, a30
    v_accvgpr_read_b32 v5, a31
    v_pk_add_f32 v[76:77], v[76:77], v[2:3]
    v_pk_add_f32 v[78:79], v[78:79], v[4:5]
    v_accvgpr_read_b32 v2, a32
    v_accvgpr_read_b32 v3, a33
    v_accvgpr_read_b32 v4, a34
    v_accvgpr_read_b32 v5, a35
    v_pk_add_f32 v[76:77], v[76:77], v[2:3]
    v_pk_add_f32 v[78:79], v[78:79], v[4:5]
    v_accvgpr_read_b32 v2, a36
    v_accvgpr_read_b32 v3, a37
    v_accvgpr_read_b32 v4, a38
    v_accvgpr_read_b32 v5, a39
    v_pk_add_f32 v[76:77], v[76:77], v[2:3]
    v_pk_add_f32 v[78:79], v[78:79], v[4:5]
    v_accvgpr_read_b32 v2, a40
    v_accvgpr_read_b32 v3, a41
    v_accvgpr_read_b32 v4, a42
    v_accvgpr_read_b32 v5, a43
    v_pk_add_f32 v[76:77], v[76:77], v[2:3]
    v_pk_add_f32 v[78:79], v[78:79], v[4:5]
    v_accvgpr_read_b32 v2, a44
    v_accvgpr_read_b32 v3, a45
    v_accvgpr_read_b32 v4, a46
    v_accvgpr_read_b32 v5, a47
    v_pk_add_f32 v[76:77], v[76:77], v[2:3]
    v_pk_add_f32 v[78:79], v[78:79], v[4:5]
    v_accvgpr_read_b32 v2, a48
    v_accvgpr_read_b32 v3, a49
    v_accvgpr_read_b32 v4, a50
    v_accvgpr_read_b32 v5, a51
    v_pk_add_f32 v[76:77], v[76:77], v[2:3]
    v_pk_add_f32 v[78:79], v[78:79], v[4:5]
    v_accvgpr_read_b32 v2, a52
    v_accvgpr_read_b32 v3, a53
    v_accvgpr_read_b32 v4, a54
    v_accvgpr_read_b32 v5, a55
    v_pk_add_f32 v[76:77], v[76:77], v[2:3]
    v_pk_add_f32 v[78:79], v[78:79], v[4:5]
    v_accvgpr_read_b32 v2, a56
    v_accvgpr_read_b32 v3, a57
    v_accvgpr_read_b32 v4, a58
    v_accvgpr_read_b32 v5, a59
    v_pk_add_f32 v[76:77], v[76:77], v[2:3]
    v_pk_add_f32 v[78:79], v[78:79], v[4:5]
    v_accvgpr_read_b32 v2, a60
    v_accvgpr_read_b32 v3, a61
    v_accvgpr_read_b32 v4, a62
    v_accvgpr_read_b32 v5, a63
    v_pk_add_f32 v[76:77], v[76:77], v[2:3]
    v_pk_add_f32 v[78:79], v[78:79], v[4:5]
    v_pk_add_f32 v[44:45], v[44:45], v[48:49]
    v_pk_add_f32 v[46:47], v[46:47], v[50:51]
    v_pk_add_f32 v[44:45], v[44:45], v[52:53]
    v_pk_add_f32 v[46:47], v[46:47], v[54:55]
    v_pk_add_f32 v[44:45], v[44:45], v[56:57]
    v_pk_add_f32 v[46:47], v[46:47], v[58:59]
    v_pk_add_f32 v[44:45], v[44:45], v[60:61]
    v_pk_add_f32 v[46:47], v[46:47], v[62:63]
    v_pk_add_f32 v[44:45], v[44:45], v[64:65]
    v_pk_add_f32 v[46:47], v[46:47], v[66:67]
    v_pk_add_f32 v[44:45], v[44:45], v[68:69]
    v_pk_add_f32 v[46:47], v[46:47], v[70:71]
    v_pk_add_f32 v[44:45], v[44:45], v[80:81]
    v_pk_add_f32 v[46:47], v[46:47], v[82:83]
    v_pk_add_f32 v[44:45], v[44:45], v[84:85]
    v_pk_add_f32 v[46:47], v[46:47], v[86:87]
    v_pk_add_f32 v[44:45], v[44:45], v[88:89]
    v_pk_add_f32 v[46:47], v[46:47], v[90:91]
    v_pk_add_f32 v[44:45], v[44:45], v[92:93]
    v_pk_add_f32 v[46:47], v[46:47], v[94:95]
    v_accvgpr_read_b32 v2, a64
    v_accvgpr_read_b32 v3, a65
    v_accvgpr_read_b32 v4, a66
    v_accvgpr_read_b32 v5, a67
    v_pk_add_f32 v[44:45], v[44:45], v[2:3]
    v_pk_add_f32 v[46:47], v[46:47], v[4:5]
    v_accvgpr_read_b32 v2, a68
    v_accvgpr_read_b32 v3, a69
    v_accvgpr_read_b32 v4, a70
    v_accvgpr_read_b32 v5, a71
    v_pk_add_f32 v[44:45], v[44:45], v[2:3]
    v_pk_add_f32 v[46:47], v[46:47], v[4:5]
    v_accvgpr_read_b32 v2, a72
    v_accvgpr_read_b32 v3, a73
    v_accvgpr_read_b32 v4, a74
    v_accvgpr_read_b32 v5, a75
    v_pk_add_f32 v[44:45], v[44:45], v[2:3]
    v_pk_add_f32 v[46:47], v[46:47], v[4:5]
    v_accvgpr_read_b32 v2, a76
    v_accvgpr_read_b32 v3, a77
    v_accvgpr_read_b32 v4, a78
    v_accvgpr_read_b32 v5, a79
    v_pk_add_f32 v[44:45], v[44:45], v[2:3]
    v_pk_add_f32 v[46:47], v[46:47], v[4:5]
    v_accvgpr_read_b32 v2, a152
    v_accvgpr_read_b32 v3, a153
    v_accvgpr_read_b32 v4, a154
    v_accvgpr_read_b32 v5, a155
    v_pk_add_f32 v[44:45], v[44:45], v[2:3]
    v_pk_add_f32 v[46:47], v[46:47], v[4:5]
    v_cvt_pk_bf16_f32 v76, v76, v77
    v_cvt_pk_bf16_f32 v77, v78, v79
    v_cvt_pk_bf16_f32 v44, v44, v45
    v_cvt_pk_bf16_f32 v45, v46, v47
    v_lshlrev_b32 v3, 3, v0
    ds_write_b64 v3, v[76:77] offset:512
    ds_write_b64 v3, v[44:45] offset:2560
    s_waitcnt lgkmcnt(0)
    v_mov_b32 v2, 288
    v_mov_b32 v3, 1
    s_mov_b64 s[56:57], exec
    s_mov_b64 exec, 1
    ds_add_u32 v2, v3
    s_mov_b64 exec, s[56:57]
    s_mov_b32 s52, 0x400000
parallel_sum__linear_kernel_hedgehog__dense_activation_squared_relu__prompt_kernel_s4_71:
    ds_read_b32 v3, v2
    s_waitcnt lgkmcnt(0)
    v_readfirstlane_b32 s53, v3
    s_nop 1
    s_cmp_ge_u32 s53, 4
    s_cbranch_scc1 parallel_sum__linear_kernel_hedgehog__dense_activation_squared_relu__prompt_kernel_s4d_72
    s_sub_u32 s52, s52, 1
    s_cmp_eq_u32 s52, 0
    s_cbranch_scc1 parallel_sum__linear_kernel_hedgehog__dense_activation_squared_relu__prompt_kernel_s4d_72
    s_sleep 1
    s_branch parallel_sum__linear_kernel_hedgehog__dense_activation_squared_relu__prompt_kernel_s4_71
parallel_sum__linear_kernel_hedgehog__dense_activation_squared_relu__prompt_kernel_s4d_72:
    v_and_b32 v2, 31, v1
    v_min_u32 v3, 20, v2
    v_mul_u32_u24 v3, 80, v3
    v_lshl_add_u32 v3, v6, 4, v3
    v_add_u32 v3, 512, v3
    v_mov_b32 v4, 7168
    v_cmp_ge_u32 vcc, 20, v2
    s_nop 1
    v_cndmask_b32 v76, v4, v3, vcc
    v_cmp_eq_u32 vcc, 24, v2
    s_nop 1
    v_cndmask_b32 v76, v76, v3, vcc
    v_cndmask_b32 v77, v76, v4, s[80:81]
    s_lshl_b32 s54, s41, 5
    v_add_u32 v2, s54, v2
    v_mul_u32_u24 v78, 160, v2
    v_lshl_add_u32 v78, v6, 4, v78
    s_mov_b32 s54, 28672
    v_add_u32 v78, s54, v78
    ds_read_b128 v[80:83], v76 offset:0
    ds_read_b128 v[60:63], v78 offset:0
    ds_read_b128 v[84:87], v76 offset:32
    ds_read_b128 v[64:67], v78 offset:32
    ds_read_b128 v[88:91], v77 offset:64
    ds_read_b128 v[68:71], v78 offset:64
    s_mul_i32 s54, s44, 5
    s_add_u32 s55, s54, 0
    v_add_u32 v2, s55, v6
    v_lshrrev_b32 v3, 2, v2
    v_and_b32 v2, 3, v2
    v_lshlrev_b32 v3, 12, v3
    v_lshl_add_u32 v79, v2, 8, v3
    s_add_u32 s55, s54, 4
    s_lshr_b32 s52, s55, 2
    s_and_b32 s55, s55, 3
    s_lshl_b32 s52, s52, 12
    s_lshl_b32 s55, s55, 8
    s_add_u32 s52, s52, s55
    s_add_u32 s52, s52, 0
    v_bfe_u32 v2, v1, 4, 1
    v_lshlrev_b32 v2, 10, v2
    v_and_b32 v3, 15, v1
    v_lshl_add_u32 v2, v3, 4, v2
    v_add_u32 v79, v79, v2
    v_add_u32 v5, s52, v2
    v_mov_b32 v4, 0x7fffff00
    v_cndmask_b32 v5, v5, v4, s[80:81]
    s_lshl_b32 s54, s43, 1
    s_lshr_b32 s55, s41, 1
    s_add_u32 s54, s54, s55
    s_mul_i32 s54, s54, 74
    s_add_u32 s54, s54, 54
    s_lshl_b32 s54, s54, 12
    s_and_b32 s55, s41, 1
    s_lshl_b32 s55, s55, 11
    s_add_u32 s54, s54, s55
    s_waitcnt lgkmcnt(4)
    v_mfma_f32_32x32x16_bf16 v[44:59], v[80:83], v[60:63], 0
    s_waitcnt lgkmcnt(2)
    v_mfma_f32_32x32x16_bf16 v[44:59], v[84:87], v[64:67], v[44:59]
    s_waitcnt lgkmcnt(0)
    v_mfma_f32_32x32x16_bf16 v[44:59], v[88:91], v[68:71], v[44:59]
    s_nop 11
    v_cndmask_b32 v2, v56, v52, s[80:81]
    v_add_f32 v2, 0x358637bd, v2
    v_rcp_f32 v2, v2
    s_nop 0
    v_mul_f32 v44, v44, v2
    v_mul_f32 v45, v45, v2
    v_mul_f32 v46, v46, v2
    v_mul_f32 v47, v47, v2
    v_mul_f32 v48, v48, v2
    v_mul_f32 v49, v49, v2
    v_mul_f32 v50, v50, v2
    v_mul_f32 v51, v51, v2
    v_mul_f32 v52, v52, v2
    v_mul_f32 v53, v53, v2
    v_mul_f32 v54, v54, v2
    v_mul_f32 v55, v55, v2
    v_cvt_pk_bf16_f32 v44, v44, v45
    v_cvt_pk_bf16_f32 v45, v46, v47
    v_cvt_pk_bf16_f32 v46, v48, v49
    v_cvt_pk_bf16_f32 v47, v50, v51
    v_cvt_pk_bf16_f32 v48, v52, v53
    v_cvt_pk_bf16_f32 v49, v54, v55
    buffer_store_dwordx4 v[44:47], v79, s[16:19], s54 offen sc1
    buffer_store_dwordx2 v[48:49], v5, s[16:19], s54 offen sc1
    v_and_b32 v2, 31, v1
    v_min_u32 v3, 20, v2
    v_mul_u32_u24 v3, 80, v3
    v_lshl_add_u32 v3, v6, 4, v3
    v_add_u32 v3, 2192, v3
    v_mov_b32 v4, 7168
    v_cmp_ge_u32 vcc, 20, v2
    s_nop 1
    v_cndmask_b32 v76, v4, v3, vcc
    v_cmp_eq_u32 vcc, 24, v2
    s_nop 1
    v_cndmask_b32 v76, v76, v3, vcc
    v_cndmask_b32 v77, v76, v4, s[80:81]
    s_lshl_b32 s54, s41, 5
    v_add_u32 v2, s54, v2
    v_mul_u32_u24 v78, 160, v2
    v_lshl_add_u32 v78, v6, 4, v78
    s_mov_b32 s54, 28752
    v_add_u32 v78, s54, v78
    ds_read_b128 v[80:83], v76 offset:0
    ds_read_b128 v[60:63], v78 offset:0
    ds_read_b128 v[84:87], v76 offset:32
    ds_read_b128 v[64:67], v78 offset:32
    ds_read_b128 v[88:91], v77 offset:64
    ds_read_b128 v[68:71], v78 offset:64
    s_mul_i32 s54, s44, 5
    s_add_u32 s55, s54, 2
    v_add_u32 v2, s55, v6
    v_lshrrev_b32 v3, 2, v2
    v_and_b32 v2, 3, v2
    v_lshlrev_b32 v3, 12, v3
    v_lshl_add_u32 v79, v2, 8, v3
    s_add_u32 s55, s54, 4
    s_lshr_b32 s52, s55, 2
    s_and_b32 s55, s55, 3
    s_lshl_b32 s52, s52, 12
    s_lshl_b32 s55, s55, 8
    s_add_u32 s52, s52, s55
    s_add_u32 s52, s52, 8
    v_bfe_u32 v2, v1, 4, 1
    v_lshlrev_b32 v2, 10, v2
    v_and_b32 v3, 15, v1
    v_lshl_add_u32 v2, v3, 4, v2
    v_add_u32 v79, v79, v2
    v_add_u32 v5, s52, v2
    v_mov_b32 v4, 0x7fffff00
    v_cndmask_b32 v5, v5, v4, s[80:81]
    s_lshl_b32 s54, s43, 1
    s_lshr_b32 s55, s41, 1
    s_add_u32 s54, s54, s55
    s_mul_i32 s54, s54, 74
    s_add_u32 s54, s54, 54
    s_lshl_b32 s54, s54, 12
    s_and_b32 s55, s41, 1
    s_lshl_b32 s55, s55, 11
    s_add_u32 s54, s54, s55
    s_waitcnt lgkmcnt(4)
    v_mfma_f32_32x32x16_bf16 v[44:59], v[80:83], v[60:63], 0
    s_waitcnt lgkmcnt(2)
    v_mfma_f32_32x32x16_bf16 v[44:59], v[84:87], v[64:67], v[44:59]
    s_waitcnt lgkmcnt(0)
    v_mfma_f32_32x32x16_bf16 v[44:59], v[88:91], v[68:71], v[44:59]
    s_nop 11
    v_cndmask_b32 v2, v56, v52, s[80:81]
    v_add_f32 v2, 0x358637bd, v2
    v_rcp_f32 v2, v2
    s_nop 0
    v_mul_f32 v44, v44, v2
    v_mul_f32 v45, v45, v2
    v_mul_f32 v46, v46, v2
    v_mul_f32 v47, v47, v2
    v_mul_f32 v48, v48, v2
    v_mul_f32 v49, v49, v2
    v_mul_f32 v50, v50, v2
    v_mul_f32 v51, v51, v2
    v_mul_f32 v52, v52, v2
    v_mul_f32 v53, v53, v2
    v_mul_f32 v54, v54, v2
    v_mul_f32 v55, v55, v2
    v_cvt_pk_bf16_f32 v44, v44, v45
    v_cvt_pk_bf16_f32 v45, v46, v47
    v_cvt_pk_bf16_f32 v46, v48, v49
    v_cvt_pk_bf16_f32 v47, v50, v51
    v_cvt_pk_bf16_f32 v48, v52, v53
    v_cvt_pk_bf16_f32 v49, v54, v55
    buffer_store_dwordx4 v[44:47], v79, s[16:19], s54 offen sc1
    buffer_store_dwordx2 v[48:49], v5, s[16:19], s54 offen sc1
    s_mov_b32 s36, s70
    s_mov_b32 s37, s71
    s_mov_b32 s38, 1280
    s_mov_b32 s12, s72
    s_mov_b32 s13, s73
    s_mov_b32 s14, 2621440
    v_lshrrev_b32 v2, 4, v1
    v_mul_u32_u24 v77, 40, v2
    s_mul_i32 s54, s46, 160
    s_mul_i32 s55, s42, 24
    s_add_u32 s54, s54, s55
    v_add_u32 v77, s54, v77
    v_and_b32 v2, 15, v1
    s_lshl_b32 s54, s45, 6
    s_lshl_b32 s55, s41, 4
    s_add_u32 s54, s54, s55
    v_add_u32 v2, s54, v2
    v_mul_u32_u24 v76, 1280, v2
    v_add_u32 v76, v76, v77
    buffer_load_dwordx4 v[80:83], v76, s[8:11], 0 offen
    buffer_load_dwordx2 v[84:85], v76, s[8:11], 0 offen offset:16
    buffer_load_dwordx4 v[88:91], v77, s[36:39], 0 offen
    buffer_load_dwordx2 v[92:93], v77, s[36:39], 0 offen offset:16
    s_waitcnt vmcnt(4)
    s_lshl_b32 s54, s43, 9
    s_lshl_b32 s55, s44, 5
    s_add_u32 s54, s54, s55
    s_lshl_b32 s55, s40, 2
    s_add_u32 s54, s54, s55
    s_add_u32 s54, s54, 12288
    v_mov_b32 v2, s54
    v_mov_b32 v3, s82
    buffer_store_dword v3, v2, s[32:35], 0 offen sc1
    s_lshl_b32 s54, s43, 9
    s_lshl_b32 s55, s44, 5
    s_add_u32 s54, s54, s55
    s_lshl_b32 s55, s40, 2
    s_add_u32 s54, s54, s55
    s_add_u32 s54, s54, 12304
    v_mov_b32 v2, s54
    v_mov_b32 v3, s82
    buffer_store_dword v3, v2, s[32:35], 0 offen sc1
    s_waitcnt vmcnt(2)
    v_lshlrev_b32 v60, 16, v80
    v_and_b32 v61, 0xffff0000, v80
    v_lshlrev_b32 v2, 16, v88
    v_and_b32 v3, 0xffff0000, v88
    v_add_f32 v60, v60, v2
    v_add_f32 v61, v61, v3
    v_lshlrev_b32 v62, 16, v81
    v_and_b32 v63, 0xffff0000, v81
    v_lshlrev_b32 v2, 16, v89
    v_and_b32 v3, 0xffff0000, v89
    v_add_f32 v62, v62, v2
    v_add_f32 v63, v63, v3
    v_lshlrev_b32 v64, 16, v82
    v_and_b32 v65, 0xffff0000, v82
    v_lshlrev_b32 v2, 16, v90
    v_and_b32 v3, 0xffff0000, v90
    v_add_f32 v64, v64, v2
    v_add_f32 v65, v65, v3
    v_lshlrev_b32 v66, 16, v83
    v_and_b32 v67, 0xffff0000, v83
    v_lshlrev_b32 v2, 16, v91
    v_and_b32 v3, 0xffff0000, v91
    v_add_f32 v66, v66, v2
    v_add_f32 v67, v67, v3
    v_lshlrev_b32 v68, 16, v84
    v_and_b32 v69, 0xffff0000, v84
    v_lshlrev_b32 v2, 16, v92
    v_and_b32 v3, 0xffff0000, v92
    v_add_f32 v68, v68, v2
    v_add_f32 v69, v69, v3
    v_lshlrev_b32 v70, 16, v85
    v_and_b32 v71, 0xffff0000, v85
    v_lshlrev_b32 v2, 16, v93
    v_and_b32 v3, 0xffff0000, v93
    v_add_f32 v70, v70, v2
    v_add_f32 v71, v71, v3
    v_lshlrev_b32 v88, 3, v1
    s_cmp_lg_u32 s40, 0
    s_cbranch_scc1 parallel_sum__linear_kernel_hedgehog__dense_activation_squared_relu__prompt_kernel_o_73
    s_lshl_b32 s54, s43, 9
    s_add_u32 s54, s54, 12288
    buffer_load_dwordx2 v[44:45], v88, s[32:35], s54 offen sc1
    s_waitcnt vmcnt(0)
    s_mov_b32 s52, 0x40000
parallel_sum__linear_kernel_hedgehog__dense_activation_squared_relu__prompt_kernel_sp_74:
    v_xor_b32 v2, s82, v44
    v_xor_b32 v3, s82, v45
    v_or_b32 v2, v2, v3
    v_cmp_ne_u32 vcc, 0, v2
    s_nop 4
    s_cbranch_vccz parallel_sum__linear_kernel_hedgehog__dense_activation_squared_relu__prompt_kernel_sd_75
    s_sub_u32 s52, s52, 1
    s_cmp_eq_u32 s52, 0
    s_cbranch_scc1 parallel_sum__linear_kernel_hedgehog__dense_activation_squared_relu__prompt_kernel_sd_75
    s_sleep 8
    s_lshl_b32 s54, s43, 9
    s_add_u32 s54, s54, 12288
    buffer_load_dwordx2 v[44:45], v88, s[32:35], s54 offen sc1
    s_waitcnt vmcnt(0)
    s_branch parallel_sum__linear_kernel_hedgehog__dense_activation_squared_relu__prompt_kernel_sp_74
parallel_sum__linear_kernel_hedgehog__dense_activation_squared_relu__prompt_kernel_sd_75:
parallel_sum__linear_kernel_hedgehog__dense_activation_squared_relu__prompt_kernel_o_73:
    s_waitcnt lgkmcnt(0)
    v_mov_b32 v2, 304
    v_mov_b32 v3, 1
    s_mov_b64 s[56:57], exec
    s_mov_b64 exec, 1
    ds_add_u32 v2, v3
    s_mov_b64 exec, s[56:57]
    s_mov_b32 s52, 0x400000
parallel_sum__linear_kernel_hedgehog__dense_activation_squared_relu__prompt_kernel_s4_76:
    ds_read_b32 v3, v2
    s_waitcnt lgkmcnt(0)
    v_readfirstlane_b32 s53, v3
    s_nop 1
    s_cmp_ge_u32 s53, 4
    s_cbranch_scc1 parallel_sum__linear_kernel_hedgehog__dense_activation_squared_relu__prompt_kernel_s4d_77
    s_sub_u32 s52, s52, 1
    s_cmp_eq_u32 s52, 0
    s_cbranch_scc1 parallel_sum__linear_kernel_hedgehog__dense_activation_squared_relu__prompt_kernel_s4d_77
    s_sleep 1
    s_branch parallel_sum__linear_kernel_hedgehog__dense_activation_squared_relu__prompt_kernel_s4_76
parallel_sum__linear_kernel_hedgehog__dense_activation_squared_relu__prompt_kernel_s4d_77:
    s_add_u32 s55, s86, 221184
    buffer_load_dwordx4 a[100:103], v74, s[16:19], s55 offen offset:0 sc1
    buffer_load_dwordx4 a[104:107], v74, s[16:19], s55 offen offset:1024 sc1
    buffer_load_dwordx4 a[108:111], v74, s[16:19], s55 offen offset:2048 sc1
    buffer_load_dwordx4 a[112:115], v74, s[16:19], s55 offen offset:3072 sc1
    s_add_u32 s55, s86, 237568
    buffer_load_dwordx4 a[136:139], v74, s[16:19], s55 offen offset:0 sc1
    buffer_load_dwordx4 a[140:143], v74, s[16:19], s55 offen offset:1024 sc1
    buffer_load_dwordx4 a[144:147], v74, s[16:19], s55 offen offset:2048 sc1
    buffer_load_dwordx4 a[148:151], v74, s[16:19], s55 offen offset:3072 sc1
    s_add_u32 s55, s86, 253952
    buffer_load_dwordx4 v[28:31], v74, s[16:19], s55 offen offset:0 sc1
    buffer_load_dwordx4 v[32:35], v74, s[16:19], s55 offen offset:1024 sc1
    buffer_load_dwordx4 v[36:39], v74, s[16:19], s55 offen offset:2048 sc1
    buffer_load_dwordx4 v[40:43], v74, s[16:19], s55 offen offset:3072 sc1
    s_waitcnt vmcnt(8)
    v_mfma_f32_16x16x32_bf16 a[0:3], a[80:83], a[100:103], 0
    v_mfma_f32_16x16x32_bf16 a[4:7], a[80:83], a[104:107], 0
    v_mfma_f32_16x16x32_bf16 a[8:11], a[80:83], a[108:111], 0
    v_mfma_f32_16x16x32_bf16 a[12:15], a[80:83], a[112:115], 0
    v_mfma_f32_16x16x32_bf16 a[16:19], a[84:87], a[100:103], 0
    v_mfma_f32_16x16x32_bf16 a[20:23], a[84:87], a[104:107], 0
    v_mfma_f32_16x16x32_bf16 a[24:27], a[84:87], a[108:111], 0
    v_mfma_f32_16x16x32_bf16 a[28:31], a[84:87], a[112:115], 0
    v_mfma_f32_16x16x32_bf16 a[32:35], a[88:91], a[100:103], 0
    v_mfma_f32_16x16x32_bf16 a[36:39], a[88:91], a[104:107], 0
    v_mfma_f32_16x16x32_bf16 a[40:43], a[88:91], a[108:111], 0
    v_mfma_f32_16x16x32_bf16 a[44:47], a[88:91], a[112:115], 0
    v_mfma_f32_16x16x32_bf16 a[48:51], a[92:95], a[100:103], 0
    v_mfma_f32_16x16x32_bf16 a[52:55], a[92:95], a[104:107], 0
    v_mfma_f32_16x16x32_bf16 a[56:59], a[92:95], a[108:111], 0
    v_mfma_f32_16x16x32_bf16 a[60:63], a[92:95], a[112:115], 0
    v_mfma_f32_16x16x32_bf16 a[64:67], a[96:99], a[100:103], 0
    v_mfma_f32_16x16x32_bf16 a[68:71], a[96:99], a[104:107], 0
    v_mfma_f32_16x16x32_bf16 a[72:75], a[96:99], a[108:111], 0
    v_mfma_f32_16x16x32_bf16 a[76:79], a[96:99], a[112:115], 0
    s_add_u32 s55, s86, 270336
    buffer_load_dwordx4 a[100:103], v74, s[16:19], s55 offen offset:0 sc1
    buffer_load_dwordx4 a[104:107], v74, s[16:19], s55 offen offset:1024 sc1
    buffer_load_dwordx4 a[108:111], v74, s[16:19], s55 offen offset:2048 sc1
    buffer_load_dwordx4 a[112:115], v74, s[16:19], s55 offen offset:3072 sc1
    s_add_u32 s54, s85, 337920
    buffer_load_dwordx4 a[80:83], v74, s[28:31], s54 offen offset:0 sc1
    buffer_load_dwordx4 a[84:87], v74, s[28:31], s54 offen offset:1024 sc1
    buffer_load_dwordx4 a[88:91], v74, s[28:31], s54 offen offset:2048 sc1
    buffer_load_dwordx4 a[92:95], v74, s[28:31], s54 offen offset:3072 sc1
    buffer_load_dwordx4 a[96:99], v72, s[28:31], s54 offen sc1
    s_waitcnt vmcnt(13)
    v_mfma_f32_16x16x32_bf16 a[0:3], a[116:119], a[136:139], a[0:3]
    v_mfma_f32_16x16x32_bf16 a[4:7], a[116:119], a[140:143], a[4:7]
    v_mfma_f32_16x16x32_bf16 a[8:11], a[116:119], a[144:147], a[8:11]
    v_mfma_f32_16x16x32_bf16 a[12:15], a[116:119], a[148:151], a[12:15]
    v_mfma_f32_16x16x32_bf16 a[16:19], a[120:123], a[136:139], a[16:19]
    v_mfma_f32_16x16x32_bf16 a[20:23], a[120:123], a[140:143], a[20:23]
    v_mfma_f32_16x16x32_bf16 a[24:27], a[120:123], a[144:147], a[24:27]
    v_mfma_f32_16x16x32_bf16 a[28:31], a[120:123], a[148:151], a[28:31]
    v_mfma_f32_16x16x32_bf16 a[32:35], a[124:127], a[136:139], a[32:35]
    v_mfma_f32_16x16x32_bf16 a[36:39], a[124:127], a[140:143], a[36:39]
    v_mfma_f32_16x16x32_bf16 a[40:43], a[124:127], a[144:147], a[40:43]
    v_mfma_f32_16x16x32_bf16 a[44:47], a[124:127], a[148:151], a[44:47]
    v_mfma_f32_16x16x32_bf16 a[48:51], a[128:131], a[136:139], a[48:51]
    v_mfma_f32_16x16x32_bf16 a[52:55], a[128:131], a[140:143], a[52:55]
    v_mfma_f32_16x16x32_bf16 a[56:59], a[128:131], a[144:147], a[56:59]
    v_mfma_f32_16x16x32_bf16 a[60:63], a[128:131], a[148:151], a[60:63]
    v_mfma_f32_16x16x32_bf16 a[64:67], a[132:135], a[136:139], a[64:67]
    v_mfma_f32_16x16x32_bf16 a[68:71], a[132:135], a[140:143], a[68:71]
    v_mfma_f32_16x16x32_bf16 a[72:75], a[132:135], a[144:147], a[72:75]
    v_mfma_f32_16x16x32_bf16 a[76:79], a[132:135], a[148:151], a[76:79]
    s_add_u32 s55, s86, 286720
    buffer_load_dwordx4 a[136:139], v74, s[16:19], s55 offen offset:0 sc1
    buffer_load_dwordx4 a[140:143], v74, s[16:19], s55 offen offset:1024 sc1
    buffer_load_dwordx4 a[144:147], v74, s[16:19], s55 offen offset:2048 sc1
    buffer_load_dwordx4 a[148:151], v74, s[16:19], s55 offen offset:3072 sc1
    s_add_u32 s54, s85, 358400
    buffer_load_dwordx4 a[116:119], v74, s[28:31], s54 offen offset:0 sc1
    buffer_load_dwordx4 a[120:123], v74, s[28:31], s54 offen offset:1024 sc1
    buffer_load_dwordx4 a[124:127], v74, s[28:31], s54 offen offset:2048 sc1
    buffer_load_dwordx4 a[128:131], v74, s[28:31], s54 offen offset:3072 sc1
    buffer_load_dwordx4 a[132:135], v72, s[28:31], s54 offen sc1
    s_waitcnt vmcnt(18)
    v_mfma_f32_16x16x32_bf16 a[0:3], v[8:11], v[28:31], a[0:3]
    v_mfma_f32_16x16x32_bf16 a[4:7], v[8:11], v[32:35], a[4:7]
    v_mfma_f32_16x16x32_bf16 a[8:11], v[8:11], v[36:39], a[8:11]
    v_mfma_f32_16x16x32_bf16 a[12:15], v[8:11], v[40:43], a[12:15]
    v_mfma_f32_16x16x32_bf16 a[16:19], v[12:15], v[28:31], a[16:19]
    v_mfma_f32_16x16x32_bf16 a[20:23], v[12:15], v[32:35], a[20:23]
    v_mfma_f32_16x16x32_bf16 a[24:27], v[12:15], v[36:39], a[24:27]
    v_mfma_f32_16x16x32_bf16 a[28:31], v[12:15], v[40:43], a[28:31]
    v_mfma_f32_16x16x32_bf16 a[32:35], v[16:19], v[28:31], a[32:35]
    v_mfma_f32_16x16x32_bf16 a[36:39], v[16:19], v[32:35], a[36:39]
    v_mfma_f32_16x16x32_bf16 a[40:43], v[16:19], v[36:39], a[40:43]
    v_mfma_f32_16x16x32_bf16 a[44:47], v[16:19], v[40:43], a[44:47]
    v_mfma_f32_16x16x32_bf16 a[48:51], v[20:23], v[28:31], a[48:51]
    v_mfma_f32_16x16x32_bf16 a[52:55], v[20:23], v[32:35], a[52:55]
    v_mfma_f32_16x16x32_bf16 a[56:59], v[20:23], v[36:39], a[56:59]
    v_mfma_f32_16x16x32_bf16 a[60:63], v[20:23], v[40:43], a[60:63]
    v_mfma_f32_16x16x32_bf16 a[64:67], v[24:27], v[28:31], a[64:67]
    v_mfma_f32_16x16x32_bf16 a[68:71], v[24:27], v[32:35], a[68:71]
    v_mfma_f32_16x16x32_bf16 a[72:75], v[24:27], v[36:39], a[72:75]
    v_mfma_f32_16x16x32_bf16 a[76:79], v[24:27], v[40:43], a[76:79]
    s_waitcnt vmcnt(9)
    v_mfma_f32_16x16x32_bf16 a[0:3], a[80:83], a[100:103], a[0:3]
    v_mfma_f32_16x16x32_bf16 a[4:7], a[80:83], a[104:107], a[4:7]
    v_mfma_f32_16x16x32_bf16 a[8:11], a[80:83], a[108:111], a[8:11]
    v_mfma_f32_16x16x32_bf16 a[12:15], a[80:83], a[112:115], a[12:15]
    v_mfma_f32_16x16x32_bf16 a[16:19], a[84:87], a[100:103], a[16:19]
    v_mfma_f32_16x16x32_bf16 a[20:23], a[84:87], a[104:107], a[20:23]
    v_mfma_f32_16x16x32_bf16 a[24:27], a[84:87], a[108:111], a[24:27]
    v_mfma_f32_16x16x32_bf16 a[28:31], a[84:87], a[112:115], a[28:31]
    v_mfma_f32_16x16x32_bf16 a[32:35], a[88:91], a[100:103], a[32:35]
    v_mfma_f32_16x16x32_bf16 a[36:39], a[88:91], a[104:107], a[36:39]
    v_mfma_f32_16x16x32_bf16 a[40:43], a[88:91], a[108:111], a[40:43]
    v_mfma_f32_16x16x32_bf16 a[44:47], a[88:91], a[112:115], a[44:47]
    v_mfma_f32_16x16x32_bf16 a[48:51], a[92:95], a[100:103], a[48:51]
    v_mfma_f32_16x16x32_bf16 a[52:55], a[92:95], a[104:107], a[52:55]
    v_mfma_f32_16x16x32_bf16 a[56:59], a[92:95], a[108:111], a[56:59]
    v_mfma_f32_16x16x32_bf16 a[60:63], a[92:95], a[112:115], a[60:63]
    v_mfma_f32_16x16x32_bf16 a[64:67], a[96:99], a[100:103], a[64:67]
    v_mfma_f32_16x16x32_bf16 a[68:71], a[96:99], a[104:107], a[68:71]
    v_mfma_f32_16x16x32_bf16 a[72:75], a[96:99], a[108:111], a[72:75]
    v_mfma_f32_16x16x32_bf16 a[76:79], a[96:99], a[112:115], a[76:79]
    s_waitcnt vmcnt(0)
    v_mfma_f32_16x16x32_bf16 a[0:3], a[116:119], a[136:139], a[0:3]
    v_mfma_f32_16x16x32_bf16 a[4:7], a[116:119], a[140:143], a[4:7]
    v_mfma_f32_16x16x32_bf16 a[8:11], a[116:119], a[144:147], a[8:11]
    v_mfma_f32_16x16x32_bf16 a[12:15], a[116:119], a[148:151], a[12:15]
    v_mfma_f32_16x16x32_bf16 a[16:19], a[120:123], a[136:139], a[16:19]
    v_mfma_f32_16x16x32_bf16 a[20:23], a[120:123], a[140:143], a[20:23]
    v_mfma_f32_16x16x32_bf16 a[24:27], a[120:123], a[144:147], a[24:27]
    v_mfma_f32_16x16x32_bf16 a[28:31], a[120:123], a[148:151], a[28:31]
    v_mfma_f32_16x16x32_bf16 a[32:35], a[124:127], a[136:139], a[32:35]
    v_mfma_f32_16x16x32_bf16 a[36:39], a[124:127], a[140:143], a[36:39]
    v_mfma_f32_16x16x32_bf16 a[40:43], a[124:127], a[144:147], a[40:43]
    v_mfma_f32_16x16x32_bf16 a[44:47], a[124:127], a[148:151], a[44:47]
    v_mfma_f32_16x16x32_bf16 a[48:51], a[128:131], a[136:139], a[48:51]
    v_mfma_f32_16x16x32_bf16 a[52:55], a[128:131], a[140:143], a[52:55]
    v_mfma_f32_16x16x32_bf16 a[56:59], a[128:131], a[144:147], a[56:59]
    v_mfma_f32_16x16x32_bf16 a[60:63], a[128:131], a[148:151], a[60:63]
    v_mfma_f32_16x16x32_bf16 a[64:67], a[132:135], a[136:139], a[64:67]
    v_mfma_f32_16x16x32_bf16 a[68:71], a[132:135], a[140:143], a[68:71]
    v_mfma_f32_16x16x32_bf16 a[72:75], a[132:135], a[144:147], a[72:75]
    v_mfma_f32_16x16x32_bf16 a[76:79], a[132:135], a[148:151], a[76:79]
    s_mul_i32 s54, s40, 20480
    v_add_u32 v78, s54, v74
    ds_write_b128 v78, a[0:3] offset:0
    ds_write_b128 v78, a[16:19] offset:1024
    ds_write_b128 v78, a[32:35] offset:2048
    ds_write_b128 v78, a[48:51] offset:3072
    ds_write_b128 v78, a[64:67] offset:4096
    ds_write_b128 v78, a[4:7] offset:5120
    ds_write_b128 v78, a[20:23] offset:6144
    ds_write_b128 v78, a[36:39] offset:7168
    ds_write_b128 v78, a[52:55] offset:8192
    ds_write_b128 v78, a[68:71] offset:9216
    ds_write_b128 v78, a[8:11] offset:10240
    ds_write_b128 v78, a[24:27] offset:11264
    ds_write_b128 v78, a[40:43] offset:12288
    ds_write_b128 v78, a[56:59] offset:13312
    ds_write_b128 v78, a[72:75] offset:14336
    ds_write_b128 v78, a[12:15] offset:15360
    ds_write_b128 v78, a[28:31] offset:16384
    ds_write_b128 v78, a[44:47] offset:17408
    ds_write_b128 v78, a[60:63] offset:18432
    ds_write_b128 v78, a[76:79] offset:19456
    s_waitcnt lgkmcnt(0)
parallel_sum__linear_kernel_hedgehog__dense_activation_squared_relu__prompt_kernel_join2:
    s_mul_i32 s54, s40, 20480
    v_add_u32 v78, s54, v74
    s_mul_i32 s54, s41, 5120
    s_mul_i32 s55, s42, 3072
    s_add_u32 s54, s54, s55
    v_add_u32 v79, s54, v74
    v_add_u32 v86, 61440, v79
    v_add_u32 v87, 0x1e000, v79
    s_barrier
    ds_read_b128 v[8:11], v79 offset:0
    ds_read_b128 v[12:15], v79 offset:20480
    ds_read_b128 v[16:19], v79 offset:40960
    ds_read_b128 v[20:23], v86 offset:0
    ds_read_b128 v[24:27], v86 offset:20480
    ds_read_b128 v[28:31], v86 offset:40960
    ds_read_b128 v[32:35], v87 offset:0
    ds_read_b128 v[36:39], v87 offset:20480
    s_waitcnt lgkmcnt(6)
    v_pk_add_f32 v[8:9], v[8:9], v[12:13]
    v_pk_add_f32 v[10:11], v[10:11], v[14:15]
    s_waitcnt lgkmcnt(5)
    v_pk_add_f32 v[8:9], v[8:9], v[16:17]
    v_pk_add_f32 v[10:11], v[10:11], v[18:19]
    s_waitcnt lgkmcnt(4)
    v_pk_add_f32 v[8:9], v[8:9], v[20:21]
    v_pk_add_f32 v[10:11], v[10:11], v[22:23]
    s_waitcnt lgkmcnt(3)
    v_pk_add_f32 v[8:9], v[8:9], v[24:25]
    v_pk_add_f32 v[10:11], v[10:11], v[26:27]
    s_waitcnt lgkmcnt(2)
    v_pk_add_f32 v[8:9], v[8:9], v[28:29]
    v_pk_add_f32 v[10:11], v[10:11], v[30:31]
    s_waitcnt lgkmcnt(1)
    v_pk_add_f32 v[8:9], v[8:9], v[32:33]
    v_pk_add_f32 v[10:11], v[10:11], v[34:35]
    s_waitcnt lgkmcnt(0)
    v_pk_add_f32 v[8:9], v[8:9], v[36:37]
    v_pk_add_f32 v[10:11], v[10:11], v[38:39]
    v_pk_add_f32 v[8:9], v[8:9], v[60:61]
    v_pk_add_f32 v[10:11], v[10:11], v[62:63]
    v_cvt_pk_bf16_f32 v80, v8, v9
    v_cvt_pk_bf16_f32 v81, v10, v11
    ds_read_b128 v[44:47], v79 offset:1024
    ds_read_b128 v[48:51], v79 offset:21504
    ds_read_b128 v[52:55], v79 offset:41984
    ds_read_b128 v[56:59], v86 offset:1024
    ds_read_b128 v[88:91], v86 offset:21504
    ds_read_b128 v[92:95], v86 offset:41984
    ds_read_b128 v[40:43], v87 offset:1024
    ds_read_b128 v[36:39], v87 offset:21504
    s_waitcnt lgkmcnt(6)
    v_pk_add_f32 v[44:45], v[44:45], v[48:49]
    v_pk_add_f32 v[46:47], v[46:47], v[50:51]
    s_waitcnt lgkmcnt(5)
    v_pk_add_f32 v[44:45], v[44:45], v[52:53]
    v_pk_add_f32 v[46:47], v[46:47], v[54:55]
    s_waitcnt lgkmcnt(4)
    v_pk_add_f32 v[44:45], v[44:45], v[56:57]
    v_pk_add_f32 v[46:47], v[46:47], v[58:59]
    s_waitcnt lgkmcnt(3)
    v_pk_add_f32 v[44:45], v[44:45], v[88:89]
    v_pk_add_f32 v[46:47], v[46:47], v[90:91]
    s_waitcnt lgkmcnt(2)
    v_pk_add_f32 v[44:45], v[44:45], v[92:93]
    v_pk_add_f32 v[46:47], v[46:47], v[94:95]
    s_waitcnt lgkmcnt(1)
    v_pk_add_f32 v[44:45], v[44:45], v[40:41]
    v_pk_add_f32 v[46:47], v[46:47], v[42:43]
    s_waitcnt lgkmcnt(0)
    v_pk_add_f32 v[44:45], v[44:45], v[36:37]
    v_pk_add_f32 v[46:47], v[46:47], v[38:39]
    v_pk_add_f32 v[44:45], v[44:45], v[64:65]
    v_pk_add_f32 v[46:47], v[46:47], v[66:67]
    v_cvt_pk_bf16_f32 v82, v44, v45
    v_cvt_pk_bf16_f32 v83, v46, v47
    ds_read_b128 v[8:11], v79 offset:2048
    ds_read_b128 v[12:15], v79 offset:22528
    ds_read_b128 v[16:19], v79 offset:43008
    ds_read_b128 v[20:23], v86 offset:2048
    ds_read_b128 v[24:27], v86 offset:22528
    ds_read_b128 v[28:31], v86 offset:43008
    ds_read_b128 v[32:35], v87 offset:2048
    ds_read_b128 v[36:39], v87 offset:22528
    s_waitcnt lgkmcnt(6)
    v_pk_add_f32 v[8:9], v[8:9], v[12:13]
    v_pk_add_f32 v[10:11], v[10:11], v[14:15]
    s_waitcnt lgkmcnt(5)
    v_pk_add_f32 v[8:9], v[8:9], v[16:17]
    v_pk_add_f32 v[10:11], v[10:11], v[18:19]
    s_waitcnt lgkmcnt(4)
    v_pk_add_f32 v[8:9], v[8:9], v[20:21]
    v_pk_add_f32 v[10:11], v[10:11], v[22:23]
    s_waitcnt lgkmcnt(3)
    v_pk_add_f32 v[8:9], v[8:9], v[24:25]
    v_pk_add_f32 v[10:11], v[10:11], v[26:27]
    s_waitcnt lgkmcnt(2)
    v_pk_add_f32 v[8:9], v[8:9], v[28:29]
    v_pk_add_f32 v[10:11], v[10:11], v[30:31]
    s_waitcnt lgkmcnt(1)
    v_pk_add_f32 v[8:9], v[8:9], v[32:33]
    v_pk_add_f32 v[10:11], v[10:11], v[34:35]
    s_waitcnt lgkmcnt(0)
    v_pk_add_f32 v[8:9], v[8:9], v[36:37]
    v_pk_add_f32 v[10:11], v[10:11], v[38:39]
    v_pk_add_f32 v[8:9], v[8:9], v[68:69]
    v_pk_add_f32 v[10:11], v[10:11], v[70:71]
    v_cvt_pk_bf16_f32 v84, v8, v9
    v_cvt_pk_bf16_f32 v85, v10, v11
    buffer_store_dwordx4 v[80:83], v76, s[12:15], 0 offen
    s_cmp_lg_u32 s42, 0
    s_cbranch_scc1 parallel_sum__linear_kernel_hedgehog__dense_activation_squared_relu__prompt_kernel_o_78
    buffer_store_dwordx2 v[84:85], v76, s[12:15], 0 offen offset:16
parallel_sum__linear_kernel_hedgehog__dense_activation_squared_relu__prompt_kernel_o_78:
parallel_sum__linear_kernel_hedgehog__dense_activation_squared_relu__prompt_kernel_done:
    s_endpgm

.section .rodata,"a"
.p2align 6
.amdhsa_kernel parallel_sum__linear_kernel_hedgehog__dense_activation_squared_relu__prompt_kernel
  .amdhsa_next_free_vgpr 256
  .amdhsa_next_free_sgpr 102
  .amdhsa_accum_offset 96
  .amdhsa_group_segment_fixed_size 0
  .amdhsa_kernarg_size 96
  .amdhsa_user_sgpr_count 2
  .amdhsa_user_sgpr_kernarg_segment_ptr 1
  .amdhsa_system_sgpr_workgroup_id_x 1
.end_amdhsa_kernel
```
